```python
import torch

def _softmax(x, axis=-1):
    return torch.softmax(x, dim=axis)
def _gelu(x):
    return torch.nn.functional.gelu(x, approximate="tanh")
def _silu(x):
    return torch.nn.functional.silu(x)
def _sigmoid(x):
    return torch.sigmoid(x)
def _layernorm(x, axis=-1, eps=1e-5):
    m = x.mean(dim=axis, keepdim=True)
    v = x.var(dim=axis, keepdim=True, unbiased=False)
    return (x - m) / torch.sqrt(v + eps)
def _scatter_add(tgt, idx, src, axis=0):
    return tgt.clone().index_add_(axis, idx, src)
def _segment_sum(src, seg, n):
    out = torch.zeros((n,) + src.shape[1:], dtype=src.dtype)
    return out.index_add_(0, seg, src)
def _pad(x, pw):
    flat = tuple(v for pair in reversed(pw) for v in pair)
    return torch.nn.functional.pad(x, flat)

kernel_name = 'sequential_preLN__softmax_full_mha__mixer_token_mlp__prompt'

def setup_inputs():

    _w = (lambda a: (lambda t: t.to(torch.bfloat16) if t.is_floating_point() else t)(torch.as_tensor(a)))
    def _A_setup():
        B, S, D = 1, 2048, 512
        return {
            "x": _w((lambda *s: torch.randn(*s, dtype=torch.bfloat16) * 0.05)(B, S, D)),
            "wqkv": _w((lambda *s: torch.randn(*s, dtype=torch.bfloat16) * 0.05)(D, 3 * D)),
            "wo": _w((lambda *s: torch.randn(*s, dtype=torch.bfloat16) * 0.05)(D, D)),
        }
    _A_in = _A_setup()

    def _B_setup():
        B, S, D, F = 1, 2048, 512, 1792
        return {
            "x": _w((lambda *s: torch.randn(*s, dtype=torch.bfloat16) * 0.05)(B, S, D)),
            "w1": _w((lambda *s: torch.randn(*s, dtype=torch.bfloat16) * 0.8)(S, F) * (S ** -0.5)),
            "b1": _w((lambda *s: torch.randn(*s, dtype=torch.bfloat16) * 12.8)(F) * 0.02),
            "w2": _w((lambda *s: torch.randn(*s, dtype=torch.bfloat16) * 0.2)(F, S) * (F ** -0.5)),
            "b2": _w((lambda *s: torch.randn(*s, dtype=torch.bfloat16) * 3.2)(S) * 0.02),
        }
    _B_in = _B_setup()

    return {
        "A_x": _A_in["x"],
        "A_wqkv": _A_in["wqkv"],
        "A_wo": _A_in["wo"],
        "B_x": _B_in["x"],
        "B_w1": _B_in["w1"],
        "B_b1": _B_in["b1"],
        "B_w2": _B_in["w2"],
        "B_b2": _B_in["b2"],
    }

def reference(A_x, A_wqkv, A_wo, B_x, B_w1, B_b1, B_w2, B_b2):
    def _A_ref(x, wqkv, wo):
        B, S, D = x.shape
        H = 32; Dh = D // H
        qkv = (lambda x, *d: x.permute(*d))((x @ wqkv).reshape(B, S, 3, H, Dh), 2, 0, 3, 1, 4)
        q, k, v = qkv[0], qkv[1], qkv[2]
        scale = Dh ** -0.5
        scores = torch.einsum("bhqd,bhkd->bhqk", q, k) * scale
        p = _softmax(scores, axis=-1)
        o = torch.einsum("bhqk,bhkd->bhqd", p, v)
        return (lambda x, *d: x.permute(*d))(o, 0, 2, 1, 3).reshape(B, S, D) @ wo

    def _B_ref(x, w1, b1, w2, b2):
        B, S, D = x.shape
        h = _layernorm(x, axis=-1)
        u = torch.einsum("bsd,sf->bdf", h, w1) + b1
        u = _gelu(u)
        y = torch.einsum("bdf,fs->bds", u, w2) + b2
        return (lambda x, *d: x.permute(*d))(y, 0, 2, 1)

    x = A_x
    h = x + _A_ref(_layernorm(x, axis=-1), A_wqkv, A_wo)
    h2 = h + _B_ref(_layernorm(h, axis=-1), B_w1, B_b1, B_w2, B_b2)
    return h2
```

```asm
; @launch grid=(256,1,1) block=(512,1,1) lds=163840
.amdgcn_target "amdgcn-amd-amdhsa--gfx950"
.text
.globl sequential_preLN__softmax_full_mha__mixer_token_mlp__prompt_kernel
.p2align 8
.type sequential_preLN__softmax_full_mha__mixer_token_mlp__prompt_kernel,@function
sequential_preLN__softmax_full_mha__mixer_token_mlp__prompt_kernel:
    s_load_dwordx4 s[4:7], s[0:1], 0
    s_cmpk_ge_u32 s2, 256
    s_cbranch_scc1 L_end
    v_readfirstlane_b32 s3, v0
    s_lshr_b32 s45, s2, 3
    v_and_b32 v0, 63, v0
    s_lshr_b32 s3, s3, 6
    s_cbranch_scc1 L_noipf
    s_getpc_b64 s[66:67]
    s_lshl_b32 s68, s45, 10
    s_min_u32 s68, s68, L_code_end-sequential_preLN__softmax_full_mha__mixer_token_mlp__prompt_kernel-1024
    s_add_u32 s66, s66, s68
    s_addc_u32 s67, s67, 0
    v_and_b32 v2, 7, v0
    v_lshlrev_b32 v2, 7, v2
    v_mov_b32 v3, 0
    v_lshl_add_u64 v[2:3], v[2:3], 0, s[66:67]
    global_load_dword a127, v[2:3], off
L_noipf:
    s_xor_b32 s44, s2, 3
    s_and_b32 s44, s44, 7
    s_add_u32 s46, s44, s45
    s_and_b32 s71, s3, 3
    v_lshrrev_b32 v1, 3, v0
    v_lshrrev_b32 v6, 4, v0
    v_xor_b32 v7, v6, v0
    v_and_b32 v7, 7, v7
    v_lshlrev_b32 v6, 2, v6
    v_xor_b32 v6, v6, v0
    v_and_b32 v5, 7, v6
    s_lshl_b32 s70, s71, 4
    v_add_u32 v4, s70, v1
    v_lshlrev_b32 v6, 6, v4
    v_add_u32 v7, v6, v7
    v_mad_u32_u24 v4, v6, 3, v5
    s_lshl_b32 s66, s44, 3
    v_add_lshl_u32 v4, v4, s66, 4
    s_lshl_b32 s66, s45, 12
    v_add_lshl_u32 v6, v7, s66, 4
    v_add_u32 v5, 23552, v4
    v_xor_b32 v7, 64, v6
    v_add_u32 v7, 7168, v7
    s_lshl_b32 s70, s70, 7
    s_mov_b32 s10, 0x180000
    s_mov_b32 s11, 0x00020000
    s_cmp_lt_u32 s3, 4
    s_waitcnt lgkmcnt(0)
    s_mov_b64 s[8:9], s[6:7]
    s_mov_b32 s7, s11
    s_mov_b32 s6, 0x200000
    s_cbranch_scc1 L_setup
    s_add_u32 s66, s46, 0
    s_and_b32 s66, s66, 7
    s_add_u32 m0, s70, 98304
    s_lshl_b32 s67, s66, 7
    buffer_load_dwordx4 v6, s[4:7], s67 offen offset:0 lds
    buffer_load_dwordx4 v7, s[4:7], s67 offen offset:1024 lds
    s_add_u32 m0, s70, 0
    s_mul_i32 s67, s66, 196608
    buffer_load_dwordx4 v4, s[8:11], s67 offen offset:0 lds
    buffer_load_dwordx4 v5, s[8:11], s67 offen offset:1024 lds
    s_add_u32 m0, s70, 8192
    s_add_u32 s67, s67, 1024
    buffer_load_dwordx4 v4, s[8:11], s67 offen offset:0 lds
    buffer_load_dwordx4 v5, s[8:11], s67 offen offset:1024 lds
    s_add_u32 m0, s70, 16384
    s_add_u32 s67, s67, 1024
    buffer_load_dwordx4 v4, s[8:11], s67 offen offset:0 lds
    buffer_load_dwordx4 v5, s[8:11], s67 offen offset:1024 lds
L_setup:
    s_load_dwordx2 s[40:41], s[0:1], 80
    s_load_dwordx2 s[36:37], s[0:1], 72
    s_load_dwordx2 s[12:13], s[0:1], 16
    s_load_dwordx2 s[16:17], s[0:1], 32
    s_load_dwordx2 s[20:21], s[0:1], 40
    s_load_dwordx2 s[24:25], s[0:1], 48
    s_load_dwordx2 s[28:29], s[0:1], 56
    s_load_dwordx2 s[32:33], s[0:1], 64
    s_mov_b32 s42, 0x1000000
    s_mov_b32 s43, 0x00020000
    s_mov_b32 s38, 0x100
    s_mov_b32 s39, 0x00020000
    s_mov_b32 s14, 0x80000
    s_mov_b32 s15, 0x00020000
    s_mov_b32 s18, 0x700000
    s_mov_b32 s19, 0x00020000
    s_mov_b32 s22, 0xe00
    s_mov_b32 s23, 0x00020000
    s_mov_b32 s26, 0x700000
    s_mov_b32 s27, 0x00020000
    s_mov_b32 s30, 0x1000
    s_mov_b32 s31, 0x00020000
    s_mov_b32 s34, 0x200000
    s_mov_b32 s35, 0x00020000
    s_mov_b32 s52, 0x100000
    s_lshr_b32 s66, s44, 1
    s_and_b32 s67, s44, 1
    s_lshr_b32 s69, s45, 3
    s_lshl2_add_u32 s48, s44, s69
    s_and_b32 s49, s45, 7
    s_and_b32 s68, s45, 3
    s_lshr_b32 s69, s45, 2
    s_lshl2_add_u32 s51, s67, s68
    s_mul_i32 s50, s66, 7
    s_add_u32 s50, s50, s69
    s_lshl2_add_u32 s47, s44, s68
    s_lshr_b32 s66, s3, 2
    s_lshl2_add_u32 s68, s69, s71
    s_lshl1_add_u32 s68, s68, s66
    s_lshl1_add_u32 s53, s47, s66
    s_lshl_b32 s53, s53, 6
    s_add_u32 s53, s53, s71
    s_lshl_b32 s53, s53, 10
    s_add_u32 s53, s53, 0x200000
    s_lshr_b32 s54, s3, 1
    s_mul_i32 s54, s54, 2080
    s_and_b32 s67, s3, 1
    s_lshl_b32 s69, s67, 10
    s_add_u32 s54, s54, s69
    s_add_u32 s54, s54, 65536
    s_lshl_b32 s55, s47, 6
    s_add_u32 s55, s55, s68
    s_lshl_b32 s55, s55, 10
    s_xor_b32 s56, s55, 1024
    s_lshl_b32 s60, s68, 5
    s_add_u32 s60, s60, s47
    s_lshl_b32 s60, s60, 10
    s_add_u32 s60, s60, 0x800000
    s_lshl_b32 s86, s3, 12
    s_add_u32 s57, s86, 98304
    s_lshl_b32 s58, s3, 10
    s_mov_b32 s59, 0
    s_mul_i32 s85, s3, 917504
    s_lshl3_add_u32 s61, s2, s3
    s_mul_i32 s61, s61, 3072
    s_add_u32 s61, s61, 0x800000
    s_lshl_b32 s68, s44, 5
    s_add_u32 s68, s68, s45
    s_lshl4_add_u32 s68, s68, 0xe18000
    s_cmp_eq_u32 s3, 4
    s_cselect_b32 s62, s68, 0x7f000000
    s_lshl_b32 s68, s48, 13
    s_add_u32 s68, s68, 0xdc0000
    s_cmp_eq_u32 s3, 7
    s_cselect_b32 s63, s68, 0x7f000000
    s_lshl1_add_u32 s68, s48, s67
    s_lshl_b32 s68, s68, 15
    s_bfe_u32 s69, s3, 0x10001
    s_lshl1_add_u32 s69, s49, s69
    s_lshl_b32 s69, s69, 6
    s_add_u32 s78, s68, s69
    s_lshl_b32 s84, s44, 13
    s_add_u32 s84, s84, 0xe00000
    s_lshl_b32 s83, s45, 2
    s_add_u32 s83, s83, s84
    s_lshl3_add_u32 s87, s50, s3
    s_lshl_b32 s87, s87, 4
    s_lshr_b32 s68, s3, 1
    s_lshl2_add_u32 s88, s48, s68
    s_lshl_b32 s88, s88, 5
    s_getreg_b32 s66, hwreg(HW_REG_XCC_ID, 0, 3)
    s_lshl_b32 s81, s3, 2
    s_lshr_b32 s81, 0x67234501, s81
    s_and_b32 s81, s81, 7
    s_add_u32 s80, s58, 0xe18000
    s_waitcnt lgkmcnt(0)
    s_add_u32 s1, s66, 1
    s_cmp_ge_u32 s45, 28
    s_cselect_b64 s[16:17], s[24:25], s[16:17]
    s_mov_b32 s66, 57344
    s_cselect_b32 s79, 16384, s66
    s_cmp_lt_u32 s3, 4
    s_cbranch_scc1 P1_compute
    v_lshlrev_b32 v3, 4, v0
    v_add_u32 v3, s70, v3
    v_add_u32 v3, 98304, v3
    v_mov_b32 v8, 0
    v_mov_b32 v9, 0
    v_mov_b32 v10, 0
    v_mov_b32 v11, 0
    v_mov_b32 v12, 0x3f803f80
    s_lshl_b32 s72, s44, 4
    s_lshl2_add_u32 s66, s44, s71
    s_lshl_b32 s66, s66, 16
    s_lshl_b32 s67, s45, 11
    s_add_u32 s66, s66, s67
    s_lshl_b32 s67, s66, 1
    s_add_u32 s67, s67, 0x200000
    v_and_b32 v14, 15, v0
    v_lshl_add_u32 v14, v14, 7, s66
    v_cmp_gt_u32 vcc, 32, v0
    v_lshl_add_u32 v15, v0, 7, s67
    v_and_b32 v13, 31, v0
    v_cndmask_b32 v14, v14, v15, vcc
    v_lshlrev_b32 v15, 2, v13
    s_add_u32 s66, s46, 1
    s_and_b32 s66, s66, 7
    s_add_u32 m0, s70, 106496
    s_lshl_b32 s67, s66, 7
    buffer_load_dwordx4 v6, s[4:7], s67 offen offset:0 lds
    buffer_load_dwordx4 v7, s[4:7], s67 offen offset:1024 lds
    s_add_u32 m0, s70, 24576
    s_mul_i32 s67, s66, 196608
    buffer_load_dwordx4 v4, s[8:11], s67 offen offset:0 lds
    buffer_load_dwordx4 v5, s[8:11], s67 offen offset:1024 lds
    s_add_u32 m0, s70, 32768
    s_add_u32 s67, s67, 1024
    buffer_load_dwordx4 v4, s[8:11], s67 offen offset:0 lds
    buffer_load_dwordx4 v5, s[8:11], s67 offen offset:1024 lds
    s_add_u32 m0, s70, 40960
    s_add_u32 s67, s67, 1024
    buffer_load_dwordx4 v4, s[8:11], s67 offen offset:0 lds
    buffer_load_dwordx4 v5, s[8:11], s67 offen offset:1024 lds
    s_setprio 1
    s_waitcnt vmcnt(8)
    ds_read_b128 v[16:19], v3 offset:0
    ds_read_b128 v[20:23], v3 offset:1024
    s_barrier
    s_add_u32 s66, s46, 2
    s_and_b32 s66, s66, 7
    s_add_u32 m0, s70, 114688
    s_lshl_b32 s67, s66, 7
    buffer_load_dwordx4 v6, s[4:7], s67 offen offset:0 lds
    buffer_load_dwordx4 v7, s[4:7], s67 offen offset:1024 lds
    s_add_u32 m0, s70, 49152
    s_mul_i32 s67, s66, 196608
    buffer_load_dwordx4 v4, s[8:11], s67 offen offset:0 lds
    buffer_load_dwordx4 v5, s[8:11], s67 offen offset:1024 lds
    s_add_u32 m0, s70, 57344
    s_add_u32 s67, s67, 1024
    buffer_load_dwordx4 v4, s[8:11], s67 offen offset:0 lds
    buffer_load_dwordx4 v5, s[8:11], s67 offen offset:1024 lds
    s_add_u32 m0, s70, 65536
    s_add_u32 s67, s67, 1024
    buffer_load_dwordx4 v4, s[8:11], s67 offen offset:0 lds
    buffer_load_dwordx4 v5, s[8:11], s67 offen offset:1024 lds
    s_waitcnt lgkmcnt(0)
    v_dot2c_f32_bf16 v8, v16, v12
    v_dot2c_f32_bf16 v10, v16, v16
    v_dot2c_f32_bf16 v8, v17, v12
    v_dot2c_f32_bf16 v10, v17, v17
    v_dot2c_f32_bf16 v8, v18, v12
    v_dot2c_f32_bf16 v10, v18, v18
    v_dot2c_f32_bf16 v8, v19, v12
    v_dot2c_f32_bf16 v10, v19, v19
    v_dot2c_f32_bf16 v9, v20, v12
    v_dot2c_f32_bf16 v11, v20, v20
    v_dot2c_f32_bf16 v9, v21, v12
    v_dot2c_f32_bf16 v11, v21, v21
    v_dot2c_f32_bf16 v9, v22, v12
    v_dot2c_f32_bf16 v11, v22, v22
    v_dot2c_f32_bf16 v9, v23, v12
    v_dot2c_f32_bf16 v11, v23, v23
    s_waitcnt vmcnt(8)
    ds_read_b128 v[16:19], v3 offset:8192
    ds_read_b128 v[20:23], v3 offset:9216
    s_barrier
    s_add_u32 s66, s46, 3
    s_and_b32 s66, s66, 7
    s_add_u32 m0, s70, 122880
    s_lshl_b32 s67, s66, 7
    buffer_load_dwordx4 v6, s[4:7], s67 offen offset:0 lds
    buffer_load_dwordx4 v7, s[4:7], s67 offen offset:1024 lds
    s_add_u32 m0, s70, 73728
    s_mul_i32 s67, s66, 196608
    buffer_load_dwordx4 v4, s[8:11], s67 offen offset:0 lds
    buffer_load_dwordx4 v5, s[8:11], s67 offen offset:1024 lds
    s_add_u32 m0, s70, 81920
    s_add_u32 s67, s67, 1024
    buffer_load_dwordx4 v4, s[8:11], s67 offen offset:0 lds
    buffer_load_dwordx4 v5, s[8:11], s67 offen offset:1024 lds
    s_add_u32 m0, s70, 90112
    s_add_u32 s67, s67, 1024
    buffer_load_dwordx4 v4, s[8:11], s67 offen offset:0 lds
    buffer_load_dwordx4 v5, s[8:11], s67 offen offset:1024 lds
    s_waitcnt lgkmcnt(0)
    v_dot2c_f32_bf16 v8, v16, v12
    v_dot2c_f32_bf16 v10, v16, v16
    v_dot2c_f32_bf16 v8, v17, v12
    v_dot2c_f32_bf16 v10, v17, v17
    v_dot2c_f32_bf16 v8, v18, v12
    v_dot2c_f32_bf16 v10, v18, v18
    v_dot2c_f32_bf16 v8, v19, v12
    v_dot2c_f32_bf16 v10, v19, v19
    v_dot2c_f32_bf16 v9, v20, v12
    v_dot2c_f32_bf16 v11, v20, v20
    v_dot2c_f32_bf16 v9, v21, v12
    v_dot2c_f32_bf16 v11, v21, v21
    v_dot2c_f32_bf16 v9, v22, v12
    v_dot2c_f32_bf16 v11, v22, v22
    v_dot2c_f32_bf16 v9, v23, v12
    v_dot2c_f32_bf16 v11, v23, v23
    s_waitcnt vmcnt(8)
    ds_read_b128 v[16:19], v3 offset:16384
    ds_read_b128 v[20:23], v3 offset:17408
    s_barrier
    s_add_u32 s66, s46, 4
    s_and_b32 s66, s66, 7
    s_add_u32 m0, s70, 131072
    s_lshl_b32 s67, s66, 7
    buffer_load_dwordx4 v6, s[4:7], s67 offen offset:0 lds
    buffer_load_dwordx4 v7, s[4:7], s67 offen offset:1024 lds
    s_add_u32 m0, s70, 0
    s_mul_i32 s67, s66, 196608
    buffer_load_dwordx4 v4, s[8:11], s67 offen offset:0 lds
    buffer_load_dwordx4 v5, s[8:11], s67 offen offset:1024 lds
    s_add_u32 m0, s70, 8192
    s_add_u32 s67, s67, 1024
    buffer_load_dwordx4 v4, s[8:11], s67 offen offset:0 lds
    buffer_load_dwordx4 v5, s[8:11], s67 offen offset:1024 lds
    s_add_u32 m0, s70, 16384
    s_add_u32 s67, s67, 1024
    buffer_load_dwordx4 v4, s[8:11], s67 offen offset:0 lds
    buffer_load_dwordx4 v5, s[8:11], s67 offen offset:1024 lds
    s_waitcnt lgkmcnt(0)
    v_dot2c_f32_bf16 v8, v16, v12
    v_dot2c_f32_bf16 v10, v16, v16
    v_dot2c_f32_bf16 v8, v17, v12
    v_dot2c_f32_bf16 v10, v17, v17
    v_dot2c_f32_bf16 v8, v18, v12
    v_dot2c_f32_bf16 v10, v18, v18
    v_dot2c_f32_bf16 v8, v19, v12
    v_dot2c_f32_bf16 v10, v19, v19
    v_dot2c_f32_bf16 v9, v20, v12
    v_dot2c_f32_bf16 v11, v20, v20
    v_dot2c_f32_bf16 v9, v21, v12
    v_dot2c_f32_bf16 v11, v21, v21
    v_dot2c_f32_bf16 v9, v22, v12
    v_dot2c_f32_bf16 v11, v22, v22
    v_dot2c_f32_bf16 v9, v23, v12
    v_dot2c_f32_bf16 v11, v23, v23
    s_waitcnt vmcnt(8)
    ds_read_b128 v[16:19], v3 offset:24576
    ds_read_b128 v[20:23], v3 offset:25600
    s_barrier
    s_add_u32 s66, s46, 5
    s_and_b32 s66, s66, 7
    s_add_u32 m0, s70, 139264
    s_lshl_b32 s67, s66, 7
    buffer_load_dwordx4 v6, s[4:7], s67 offen offset:0 lds
    buffer_load_dwordx4 v7, s[4:7], s67 offen offset:1024 lds
    s_add_u32 m0, s70, 24576
    s_mul_i32 s67, s66, 196608
    buffer_load_dwordx4 v4, s[8:11], s67 offen offset:0 lds
    buffer_load_dwordx4 v5, s[8:11], s67 offen offset:1024 lds
    s_add_u32 m0, s70, 32768
    s_add_u32 s67, s67, 1024
    buffer_load_dwordx4 v4, s[8:11], s67 offen offset:0 lds
    buffer_load_dwordx4 v5, s[8:11], s67 offen offset:1024 lds
    s_add_u32 m0, s70, 40960
    s_add_u32 s67, s67, 1024
    buffer_load_dwordx4 v4, s[8:11], s67 offen offset:0 lds
    buffer_load_dwordx4 v5, s[8:11], s67 offen offset:1024 lds
    s_waitcnt lgkmcnt(0)
    v_dot2c_f32_bf16 v8, v16, v12
    v_dot2c_f32_bf16 v10, v16, v16
    v_dot2c_f32_bf16 v8, v17, v12
    v_dot2c_f32_bf16 v10, v17, v17
    v_dot2c_f32_bf16 v8, v18, v12
    v_dot2c_f32_bf16 v10, v18, v18
    v_dot2c_f32_bf16 v8, v19, v12
    v_dot2c_f32_bf16 v10, v19, v19
    v_dot2c_f32_bf16 v9, v20, v12
    v_dot2c_f32_bf16 v11, v20, v20
    v_dot2c_f32_bf16 v9, v21, v12
    v_dot2c_f32_bf16 v11, v21, v21
    v_dot2c_f32_bf16 v9, v22, v12
    v_dot2c_f32_bf16 v11, v22, v22
    v_dot2c_f32_bf16 v9, v23, v12
    v_dot2c_f32_bf16 v11, v23, v23
    s_waitcnt vmcnt(8)
    ds_read_b128 v[16:19], v3 offset:32768
    ds_read_b128 v[20:23], v3 offset:33792
    s_barrier
    s_add_u32 s66, s46, 6
    s_and_b32 s66, s66, 7
    s_add_u32 m0, s70, 147456
    s_lshl_b32 s67, s66, 7
    buffer_load_dwordx4 v6, s[4:7], s67 offen offset:0 lds
    buffer_load_dwordx4 v7, s[4:7], s67 offen offset:1024 lds
    s_add_u32 m0, s70, 49152
    s_mul_i32 s67, s66, 196608
    buffer_load_dwordx4 v4, s[8:11], s67 offen offset:0 lds
    buffer_load_dwordx4 v5, s[8:11], s67 offen offset:1024 lds
    s_add_u32 m0, s70, 57344
    s_add_u32 s67, s67, 1024
    buffer_load_dwordx4 v4, s[8:11], s67 offen offset:0 lds
    buffer_load_dwordx4 v5, s[8:11], s67 offen offset:1024 lds
    s_add_u32 m0, s70, 65536
    s_add_u32 s67, s67, 1024
    buffer_load_dwordx4 v4, s[8:11], s67 offen offset:0 lds
    buffer_load_dwordx4 v5, s[8:11], s67 offen offset:1024 lds
    s_waitcnt lgkmcnt(0)
    v_dot2c_f32_bf16 v8, v16, v12
    v_dot2c_f32_bf16 v10, v16, v16
    v_dot2c_f32_bf16 v8, v17, v12
    v_dot2c_f32_bf16 v10, v17, v17
    v_dot2c_f32_bf16 v8, v18, v12
    v_dot2c_f32_bf16 v10, v18, v18
    v_dot2c_f32_bf16 v8, v19, v12
    v_dot2c_f32_bf16 v10, v19, v19
    v_dot2c_f32_bf16 v9, v20, v12
    v_dot2c_f32_bf16 v11, v20, v20
    v_dot2c_f32_bf16 v9, v21, v12
    v_dot2c_f32_bf16 v11, v21, v21
    v_dot2c_f32_bf16 v9, v22, v12
    v_dot2c_f32_bf16 v11, v22, v22
    v_dot2c_f32_bf16 v9, v23, v12
    v_dot2c_f32_bf16 v11, v23, v23
    s_waitcnt vmcnt(8)
    ds_read_b128 v[16:19], v3 offset:40960
    ds_read_b128 v[20:23], v3 offset:41984
    s_barrier
    s_add_u32 s66, s46, 7
    s_and_b32 s66, s66, 7
    s_add_u32 m0, s70, 155648
    s_lshl_b32 s67, s66, 7
    buffer_load_dwordx4 v6, s[4:7], s67 offen offset:0 lds
    buffer_load_dwordx4 v7, s[4:7], s67 offen offset:1024 lds
    s_add_u32 m0, s70, 73728
    s_mul_i32 s67, s66, 196608
    buffer_load_dwordx4 v4, s[8:11], s67 offen offset:0 lds
    buffer_load_dwordx4 v5, s[8:11], s67 offen offset:1024 lds
    s_add_u32 m0, s70, 81920
    s_add_u32 s67, s67, 1024
    buffer_load_dwordx4 v4, s[8:11], s67 offen offset:0 lds
    buffer_load_dwordx4 v5, s[8:11], s67 offen offset:1024 lds
    s_add_u32 m0, s70, 90112
    s_add_u32 s67, s67, 1024
    buffer_load_dwordx4 v4, s[8:11], s67 offen offset:0 lds
    buffer_load_dwordx4 v5, s[8:11], s67 offen offset:1024 lds
    s_waitcnt lgkmcnt(0)
    v_dot2c_f32_bf16 v8, v16, v12
    v_dot2c_f32_bf16 v10, v16, v16
    v_dot2c_f32_bf16 v8, v17, v12
    v_dot2c_f32_bf16 v10, v17, v17
    v_dot2c_f32_bf16 v8, v18, v12
    v_dot2c_f32_bf16 v10, v18, v18
    v_dot2c_f32_bf16 v8, v19, v12
    v_dot2c_f32_bf16 v10, v19, v19
    v_dot2c_f32_bf16 v9, v20, v12
    v_dot2c_f32_bf16 v11, v20, v20
    v_dot2c_f32_bf16 v9, v21, v12
    v_dot2c_f32_bf16 v11, v21, v21
    v_dot2c_f32_bf16 v9, v22, v12
    v_dot2c_f32_bf16 v11, v22, v22
    v_dot2c_f32_bf16 v9, v23, v12
    v_dot2c_f32_bf16 v11, v23, v23
    s_waitcnt vmcnt(8)
    ds_read_b128 v[16:19], v3 offset:49152
    ds_read_b128 v[20:23], v3 offset:50176
    s_barrier
    buffer_load_dword v94, off, s[36:39], s72 sc1
    buffer_load_dword v95, v14, s[40:43], 0 offen sc1
    s_waitcnt lgkmcnt(0)
    v_dot2c_f32_bf16 v8, v16, v12
    v_dot2c_f32_bf16 v10, v16, v16
    v_dot2c_f32_bf16 v8, v17, v12
    v_dot2c_f32_bf16 v10, v17, v17
    v_dot2c_f32_bf16 v8, v18, v12
    v_dot2c_f32_bf16 v10, v18, v18
    v_dot2c_f32_bf16 v8, v19, v12
    v_dot2c_f32_bf16 v10, v19, v19
    v_dot2c_f32_bf16 v9, v20, v12
    v_dot2c_f32_bf16 v11, v20, v20
    v_dot2c_f32_bf16 v9, v21, v12
    v_dot2c_f32_bf16 v11, v21, v21
    v_dot2c_f32_bf16 v9, v22, v12
    v_dot2c_f32_bf16 v11, v22, v22
    v_dot2c_f32_bf16 v9, v23, v12
    v_dot2c_f32_bf16 v11, v23, v23
    s_waitcnt vmcnt(2)
    ds_read_b128 v[16:19], v3 offset:57344
    ds_read_b128 v[20:23], v3 offset:58368
    s_barrier
    s_waitcnt lgkmcnt(0)
    v_dot2c_f32_bf16 v8, v16, v12
    v_dot2c_f32_bf16 v10, v16, v16
    v_dot2c_f32_bf16 v8, v17, v12
    v_dot2c_f32_bf16 v10, v17, v17
    v_dot2c_f32_bf16 v8, v18, v12
    v_dot2c_f32_bf16 v10, v18, v18
    v_dot2c_f32_bf16 v8, v19, v12
    v_dot2c_f32_bf16 v10, v19, v19
    v_dot2c_f32_bf16 v9, v20, v12
    v_dot2c_f32_bf16 v11, v20, v20
    v_dot2c_f32_bf16 v9, v21, v12
    v_dot2c_f32_bf16 v11, v21, v21
    v_dot2c_f32_bf16 v9, v22, v12
    v_dot2c_f32_bf16 v11, v22, v22
    v_dot2c_f32_bf16 v9, v23, v12
    v_dot2c_f32_bf16 v11, v23, v23
    s_mov_b32 s66, 0x3b000000
    s_mov_b32 s67, 0x3727c5ac
    s_nop 0
    v_add_f32_dpp v8, v8, v8 quad_perm:[1,0,3,2] row_mask:0xf bank_mask:0xf
    v_add_f32_dpp v9, v9, v9 quad_perm:[1,0,3,2] row_mask:0xf bank_mask:0xf
    v_add_f32_dpp v10, v10, v10 quad_perm:[1,0,3,2] row_mask:0xf bank_mask:0xf
    v_add_f32_dpp v11, v11, v11 quad_perm:[1,0,3,2] row_mask:0xf bank_mask:0xf
    v_add_f32_dpp v8, v8, v8 quad_perm:[2,3,0,1] row_mask:0xf bank_mask:0xf
    v_add_f32_dpp v9, v9, v9 quad_perm:[2,3,0,1] row_mask:0xf bank_mask:0xf
    v_add_f32_dpp v10, v10, v10 quad_perm:[2,3,0,1] row_mask:0xf bank_mask:0xf
    v_add_f32_dpp v11, v11, v11 quad_perm:[2,3,0,1] row_mask:0xf bank_mask:0xf
    v_add_f32_dpp v8, v8, v8 row_half_mirror row_mask:0xf bank_mask:0xf
    v_add_f32_dpp v9, v9, v9 row_half_mirror row_mask:0xf bank_mask:0xf
    v_add_f32_dpp v10, v10, v10 row_half_mirror row_mask:0xf bank_mask:0xf
    v_add_f32_dpp v11, v11, v11 row_half_mirror row_mask:0xf bank_mask:0xf
    v_mul_f32 v8, s66, v8
    v_mul_f32 v9, s66, v9
    v_mul_f32 v10, s66, v10
    v_mul_f32 v11, s66, v11
    v_fma_f32 v10, -v8, v8, v10
    v_fma_f32 v11, -v9, v9, v11
    v_max_f32 v10, 0, v10
    v_max_f32 v11, 0, v11
    v_add_f32 v10, s67, v10
    v_add_f32 v11, s67, v11
    v_rsq_f32 v10, v10
    v_rsq_f32 v11, v11
    s_lshl_b32 s66, s71, 6
    s_add_u32 s66, s66, 102400
    v_lshl_add_u32 v3, v1, 2, s66
    ds_write2_b32 v3, v8, v9 offset0:0 offset1:8
    ds_write2_b32 v3, v10, v11 offset0:64 offset1:72
    s_waitcnt lgkmcnt(0)
    s_setprio 0
    s_barrier
    s_waitcnt vmcnt(1)
P1_g:
    v_cmp_eq_u32 vcc, 0, v94
    s_cbranch_vccz P1_g_ok
    buffer_load_dword v94, off, s[36:39], s72 sc1
    s_waitcnt vmcnt(0)
    s_sub_u32 s52, s52, 1
    s_cbranch_scc0 P1_g
    s_mov_b32 s52, 0
P1_g_ok:
    buffer_load_dword v95, v15, s[40:43], s84 offen sc1
    s_branch P1_done
P1_compute:
    s_xor_b32 s66, s3, 1
    s_or_b32 s66, s66, s45
    s_cmp_lg_u32 s66, 0
    s_cbranch_scc1 P1_nopost
    s_lshl_b32 s67, s44, 9
    s_add_u32 s67, s67, 0xe18000
    v_mov_b32 v12, 0
    v_mov_b32 v13, 0
    v_mov_b32 v14, 0
    v_lshlrev_b32 v15, 2, v0
    buffer_store_dword v14, v15, s[40:43], s84 offen sc1
    v_lshlrev_b32 v15, 3, v0
    buffer_store_dwordx2 v[12:13], v15, s[40:43], s67 offen sc1
    s_lshl_b32 s67, s44, 4
    v_mov_b32 v15, 1
    s_waitcnt vmcnt(0)
    buffer_store_dword v15, off, s[36:39], s67 sc1
P1_nopost:
    s_and_b32 s71, s3, 1
    s_lshr_b32 s72, s3, 1
    v_and_b32 v1, 31, v0
    v_lshrrev_b32 v2, 5, v0
    s_lshl_b32 s66, s71, 5
    v_add_u32 v3, s66, v1
    v_bfe_u32 v4, v3, 1, 3
    v_xor_b32 v4, v4, v2
    v_lshlrev_b32 v4, 4, v4
    s_lshl_b32 s66, s71, 6
    v_xor_b32 v4, s66, v4
    v_lshl_add_u32 v4, v3, 7, v4
    v_add_u32 v4, 98304, v4
    v_xor_b32 v5, 32, v4
    v_xor_b32 v6, 64, v4
    v_xor_b32 v7, 96, v4
    v_bfe_u32 v9, v0, 2, 2
    v_lshl_add_u32 v10, v2, 3, v9
    v_lshlrev_b32 v10, 7, v10
    v_bfe_u32 v11, v0, 4, 1
    v_lshlrev_b32 v11, 2, v11
    v_and_b32 v14, 3, v0
    v_add_u32 v11, v11, v14
    s_lshl_b32 s66, s72, 3
    v_add_u32 v11, s66, v11
    v_lshrrev_b32 v14, 1, v9
    v_lshlrev_b32 v14, 3, v14
    v_xor_b32 v11, v11, v14
    v_lshl_add_u32 v8, v11, 3, v10
    s_lshl_b32 s66, s71, 12
    v_add_u32 v8, s66, v8
    v_xor_b32 v9, 4096, v8
    v_lshrrev_b32 v10, 4, v0
    v_mul_u32_u24 v10, 20, v10
    v_cmp_eq_u32 vcc, v10, v0
    v_mov_b32 v10, 0x3f803f80
    v_add_u32 v11, 49152, v9
    v_cndmask_b32 v12, 0, v10, vcc
    v_cndmask_b32 v13, 0, v10, vcc
    v_cndmask_b32 v14, 0, v10, vcc
    v_cndmask_b32 v15, 0, v10, vcc
    v_add_u32 v10, 49152, v8
    s_lshl1_add_u32 s66, s45, s71
    s_lshl1_add_u32 s67, s44, s72
    s_lshl_b32 s67, s67, 17
    s_lshl_b32 s66, s66, 10
    s_add_u32 s74, s66, s67
    s_add_u32 s75, s74, 0x10000
    s_lshl_b32 s76, s74, 1
    s_add_u32 s76, s76, 0x200000
    s_add_u32 s77, s76, 0x20000
    v_lshlrev_b32 v112, 4, v0
    v_bfe_u32 v113, v0, 2, 1
    v_bfe_u32 v114, v0, 3, 1
    v_and_b32 v115, 0x33, v0
    v_lshl_add_u32 v115, v113, 3, v115
    v_lshl_add_u32 v115, v114, 2, v115
    v_lshlrev_b32 v113, 4, v115
    v_bfe_u32 v114, v0, 4, 1
    v_lshlrev_b32 v114, 17, v114
    v_and_b32 v115, 15, v0
    v_lshl_add_u32 v114, v115, 4, v114
    v_lshl_add_u32 v114, v2, 8, v114
    s_add_u32 s66, s58, 98304
    v_add_u32 v115, s66, v112
    v_xor_b32 v116, 1024, v115
    v_lshlrev_b32 v117, 2, v3
    v_add_u32 v117, 102400, v117
    s_lshl_b32 s66, s71, 7
    s_add_u32 s66, s66, 102656
    v_lshl_add_u32 v118, v2, 4, s66
    s_barrier
    ds_read_b128 v[64:67], v4 offset:0
    ds_read_b64_tr_b16 v[68:69], v8 offset:0
    ds_read_b64_tr_b16 v[70:71], v8 offset:512
    ds_read_b64_tr_b16 v[72:73], v8 offset:8192
    ds_read_b64_tr_b16 v[74:75], v8 offset:8704
    ds_read_b64_tr_b16 v[76:77], v8 offset:16384
    ds_read_b64_tr_b16 v[78:79], v8 offset:16896
    ds_read_b128 v[80:83], v5 offset:0
    ds_read_b64_tr_b16 v[84:85], v8 offset:2048
    ds_read_b64_tr_b16 v[86:87], v8 offset:2560
    ds_read_b64_tr_b16 v[88:89], v8 offset:10240
    ds_read_b64_tr_b16 v[90:91], v8 offset:10752
    ds_read_b64_tr_b16 v[92:93], v8 offset:18432
    ds_read_b64_tr_b16 v[94:95], v8 offset:18944
    s_waitcnt lgkmcnt(7)
    v_mfma_f32_32x32x16_bf16 v[16:31], v[68:71], v[64:67], 0
    ds_read_b128 v[96:99], v6 offset:0
    ds_read_b64_tr_b16 v[100:101], v9 offset:0
    ds_read_b64_tr_b16 v[102:103], v9 offset:512
    v_mfma_f32_16x16x32_bf16 a[0:3], v[12:15], v[68:71], 0
    v_mfma_f32_32x32x16_bf16 v[32:47], v[72:75], v[64:67], 0
    ds_read_b64_tr_b16 v[104:105], v9 offset:8192
    ds_read_b64_tr_b16 v[106:107], v9 offset:8704
    v_mfma_f32_16x16x32_bf16 a[4:7], v[12:15], v[72:75], 0
    v_mfma_f32_32x32x16_bf16 v[48:63], v[64:67], v[76:79], 0
    ds_read_b64_tr_b16 v[108:109], v9 offset:16384
    ds_read_b64_tr_b16 v[110:111], v9 offset:16896
    v_mfma_f32_16x16x32_bf16 a[8:11], v[12:15], v[76:79], 0
    s_waitcnt lgkmcnt(7)
    v_mfma_f32_32x32x16_bf16 v[16:31], v[84:87], v[80:83], v[16:31]
    ds_read_b128 v[64:67], v7 offset:0
    ds_read_b64_tr_b16 v[68:69], v9 offset:2048
    ds_read_b64_tr_b16 v[70:71], v9 offset:2560
    v_mfma_f32_16x16x32_bf16 a[0:3], v[12:15], v[84:87], a[0:3]
    v_mfma_f32_32x32x16_bf16 v[32:47], v[88:91], v[80:83], v[32:47]
    ds_read_b64_tr_b16 v[72:73], v9 offset:10240
    ds_read_b64_tr_b16 v[74:75], v9 offset:10752
    v_mfma_f32_16x16x32_bf16 a[4:7], v[12:15], v[88:91], a[4:7]
    v_mfma_f32_32x32x16_bf16 v[48:63], v[80:83], v[92:95], v[48:63]
    ds_read_b64_tr_b16 v[76:77], v9 offset:18432
    ds_read_b64_tr_b16 v[78:79], v9 offset:18944
    v_mfma_f32_16x16x32_bf16 a[8:11], v[12:15], v[92:95], a[8:11]
    s_waitcnt lgkmcnt(7)
    v_mfma_f32_32x32x16_bf16 v[16:31], v[100:103], v[96:99], v[16:31]
    s_barrier
    ds_read_b128 v[80:83], v4 offset:8192
    ds_read_b64_tr_b16 v[84:85], v8 offset:24576
    ds_read_b64_tr_b16 v[86:87], v8 offset:25088
    v_mfma_f32_32x32x16_bf16 v[32:47], v[104:107], v[96:99], v[32:47]
    ds_read_b64_tr_b16 v[88:89], v8 offset:32768
    ds_read_b64_tr_b16 v[90:91], v8 offset:33280
    v_mfma_f32_32x32x16_bf16 v[48:63], v[96:99], v[108:111], v[48:63]
    ds_read_b64_tr_b16 v[92:93], v8 offset:40960
    ds_read_b64_tr_b16 v[94:95], v8 offset:41472
    s_waitcnt lgkmcnt(7)
    v_mfma_f32_32x32x16_bf16 v[16:31], v[68:71], v[64:67], v[16:31]
    ds_read_b128 v[96:99], v5 offset:8192
    ds_read_b64_tr_b16 v[100:101], v8 offset:26624
    ds_read_b64_tr_b16 v[102:103], v8 offset:27136
    v_mfma_f32_32x32x16_bf16 v[32:47], v[72:75], v[64:67], v[32:47]
    ds_read_b64_tr_b16 v[104:105], v8 offset:34816
    ds_read_b64_tr_b16 v[106:107], v8 offset:35328
    v_mfma_f32_32x32x16_bf16 v[48:63], v[64:67], v[76:79], v[48:63]
    ds_read_b64_tr_b16 v[108:109], v8 offset:43008
    ds_read_b64_tr_b16 v[110:111], v8 offset:43520
    s_waitcnt lgkmcnt(7)
    v_mfma_f32_32x32x16_bf16 v[16:31], v[84:87], v[80:83], v[16:31]
    ds_read_b128 v[64:67], v6 offset:8192
    ds_read_b64_tr_b16 v[68:69], v9 offset:24576
    ds_read_b64_tr_b16 v[70:71], v9 offset:25088
    v_mfma_f32_16x16x32_bf16 a[0:3], v[12:15], v[84:87], a[0:3]
    v_mfma_f32_32x32x16_bf16 v[32:47], v[88:91], v[80:83], v[32:47]
    ds_read_b64_tr_b16 v[72:73], v9 offset:32768
    ds_read_b64_tr_b16 v[74:75], v9 offset:33280
    v_mfma_f32_16x16x32_bf16 a[4:7], v[12:15], v[88:91], a[4:7]
    v_mfma_f32_32x32x16_bf16 v[48:63], v[80:83], v[92:95], v[48:63]
    ds_read_b64_tr_b16 v[76:77], v9 offset:40960
    ds_read_b64_tr_b16 v[78:79], v9 offset:41472
    v_mfma_f32_16x16x32_bf16 a[8:11], v[12:15], v[92:95], a[8:11]
    s_waitcnt lgkmcnt(7)
    v_mfma_f32_32x32x16_bf16 v[16:31], v[100:103], v[96:99], v[16:31]
    ds_read_b128 v[80:83], v7 offset:8192
    ds_read_b64_tr_b16 v[84:85], v9 offset:26624
    ds_read_b64_tr_b16 v[86:87], v9 offset:27136
    v_mfma_f32_16x16x32_bf16 a[0:3], v[12:15], v[100:103], a[0:3]
    v_mfma_f32_32x32x16_bf16 v[32:47], v[104:107], v[96:99], v[32:47]
    ds_read_b64_tr_b16 v[88:89], v9 offset:34816
    ds_read_b64_tr_b16 v[90:91], v9 offset:35328
    v_mfma_f32_16x16x32_bf16 a[4:7], v[12:15], v[104:107], a[4:7]
    v_mfma_f32_32x32x16_bf16 v[48:63], v[96:99], v[108:111], v[48:63]
    ds_read_b64_tr_b16 v[92:93], v9 offset:43008
    ds_read_b64_tr_b16 v[94:95], v9 offset:43520
    v_mfma_f32_16x16x32_bf16 a[8:11], v[12:15], v[108:111], a[8:11]
    s_waitcnt lgkmcnt(7)
    v_mfma_f32_32x32x16_bf16 v[16:31], v[68:71], v[64:67], v[16:31]
    s_barrier
    ds_read_b128 v[96:99], v4 offset:16384
    ds_read_b64_tr_b16 v[100:101], v10 offset:0
    ds_read_b64_tr_b16 v[102:103], v10 offset:512
    v_mfma_f32_32x32x16_bf16 v[32:47], v[72:75], v[64:67], v[32:47]
    ds_read_b64_tr_b16 v[104:105], v10 offset:8192
    ds_read_b64_tr_b16 v[106:107], v10 offset:8704
    v_mfma_f32_32x32x16_bf16 v[48:63], v[64:67], v[76:79], v[48:63]
    ds_read_b64_tr_b16 v[108:109], v10 offset:16384
    ds_read_b64_tr_b16 v[110:111], v10 offset:16896
    s_waitcnt lgkmcnt(7)
    v_mfma_f32_32x32x16_bf16 v[16:31], v[84:87], v[80:83], v[16:31]
    ds_read_b128 v[64:67], v5 offset:16384
    ds_read_b64_tr_b16 v[68:69], v10 offset:2048
    ds_read_b64_tr_b16 v[70:71], v10 offset:2560
    v_mfma_f32_32x32x16_bf16 v[32:47], v[88:91], v[80:83], v[32:47]
    ds_read_b64_tr_b16 v[72:73], v10 offset:10240
    ds_read_b64_tr_b16 v[74:75], v10 offset:10752
    v_mfma_f32_32x32x16_bf16 v[48:63], v[80:83], v[92:95], v[48:63]
    ds_read_b64_tr_b16 v[76:77], v10 offset:18432
    ds_read_b64_tr_b16 v[78:79], v10 offset:18944
    s_waitcnt lgkmcnt(7)
    v_mfma_f32_32x32x16_bf16 v[16:31], v[100:103], v[96:99], v[16:31]
    ds_read_b128 v[80:83], v6 offset:16384
    ds_read_b64_tr_b16 v[84:85], v11 offset:0
    ds_read_b64_tr_b16 v[86:87], v11 offset:512
    v_mfma_f32_16x16x32_bf16 a[0:3], v[12:15], v[100:103], a[0:3]
    v_mfma_f32_32x32x16_bf16 v[32:47], v[104:107], v[96:99], v[32:47]
    ds_read_b64_tr_b16 v[88:89], v11 offset:8192
    ds_read_b64_tr_b16 v[90:91], v11 offset:8704
    v_mfma_f32_16x16x32_bf16 a[4:7], v[12:15], v[104:107], a[4:7]
    v_mfma_f32_32x32x16_bf16 v[48:63], v[96:99], v[108:111], v[48:63]
    ds_read_b64_tr_b16 v[92:93], v11 offset:16384
    ds_read_b64_tr_b16 v[94:95], v11 offset:16896
    v_mfma_f32_16x16x32_bf16 a[8:11], v[12:15], v[108:111], a[8:11]
    s_waitcnt lgkmcnt(7)
    v_mfma_f32_32x32x16_bf16 v[16:31], v[68:71], v[64:67], v[16:31]
    ds_read_b128 v[96:99], v7 offset:16384
    ds_read_b64_tr_b16 v[100:101], v11 offset:2048
    ds_read_b64_tr_b16 v[102:103], v11 offset:2560
    v_mfma_f32_16x16x32_bf16 a[0:3], v[12:15], v[68:71], a[0:3]
    v_mfma_f32_32x32x16_bf16 v[32:47], v[72:75], v[64:67], v[32:47]
    ds_read_b64_tr_b16 v[104:105], v11 offset:10240
    ds_read_b64_tr_b16 v[106:107], v11 offset:10752
    v_mfma_f32_16x16x32_bf16 a[4:7], v[12:15], v[72:75], a[4:7]
    v_mfma_f32_32x32x16_bf16 v[48:63], v[64:67], v[76:79], v[48:63]
    ds_read_b64_tr_b16 v[108:109], v11 offset:18432
    ds_read_b64_tr_b16 v[110:111], v11 offset:18944
    v_mfma_f32_16x16x32_bf16 a[8:11], v[12:15], v[76:79], a[8:11]
    s_waitcnt lgkmcnt(7)
    v_mfma_f32_32x32x16_bf16 v[16:31], v[84:87], v[80:83], v[16:31]
    s_barrier
    ds_read_b128 v[64:67], v4 offset:24576
    ds_read_b64_tr_b16 v[68:69], v10 offset:24576
    ds_read_b64_tr_b16 v[70:71], v10 offset:25088
    v_mfma_f32_32x32x16_bf16 v[32:47], v[88:91], v[80:83], v[32:47]
    ds_read_b64_tr_b16 v[72:73], v10 offset:32768
    ds_read_b64_tr_b16 v[74:75], v10 offset:33280
    v_mfma_f32_32x32x16_bf16 v[48:63], v[80:83], v[92:95], v[48:63]
    ds_read_b64_tr_b16 v[76:77], v10 offset:40960
    ds_read_b64_tr_b16 v[78:79], v10 offset:41472
    s_waitcnt lgkmcnt(7)
    v_mfma_f32_32x32x16_bf16 v[16:31], v[100:103], v[96:99], v[16:31]
    ds_read_b128 v[80:83], v5 offset:24576
    ds_read_b64_tr_b16 v[84:85], v10 offset:26624
    ds_read_b64_tr_b16 v[86:87], v10 offset:27136
    v_mfma_f32_32x32x16_bf16 v[32:47], v[104:107], v[96:99], v[32:47]
    ds_read_b64_tr_b16 v[88:89], v10 offset:34816
    ds_read_b64_tr_b16 v[90:91], v10 offset:35328
    v_mfma_f32_32x32x16_bf16 v[48:63], v[96:99], v[108:111], v[48:63]
    ds_read_b64_tr_b16 v[92:93], v10 offset:43008
    ds_read_b64_tr_b16 v[94:95], v10 offset:43520
    s_waitcnt lgkmcnt(7)
    v_mfma_f32_32x32x16_bf16 v[16:31], v[68:71], v[64:67], v[16:31]
    ds_read_b128 v[96:99], v6 offset:24576
    ds_read_b64_tr_b16 v[100:101], v11 offset:24576
    ds_read_b64_tr_b16 v[102:103], v11 offset:25088
    v_mfma_f32_16x16x32_bf16 a[0:3], v[12:15], v[68:71], a[0:3]
    v_mfma_f32_32x32x16_bf16 v[32:47], v[72:75], v[64:67], v[32:47]
    ds_read_b64_tr_b16 v[104:105], v11 offset:32768
    ds_read_b64_tr_b16 v[106:107], v11 offset:33280
    v_mfma_f32_16x16x32_bf16 a[4:7], v[12:15], v[72:75], a[4:7]
    v_mfma_f32_32x32x16_bf16 v[48:63], v[64:67], v[76:79], v[48:63]
    ds_read_b64_tr_b16 v[108:109], v11 offset:40960
    ds_read_b64_tr_b16 v[110:111], v11 offset:41472
    v_mfma_f32_16x16x32_bf16 a[8:11], v[12:15], v[76:79], a[8:11]
    s_waitcnt lgkmcnt(7)
    v_mfma_f32_32x32x16_bf16 v[16:31], v[84:87], v[80:83], v[16:31]
    ds_read_b128 v[64:67], v7 offset:24576
    ds_read_b64_tr_b16 v[68:69], v11 offset:26624
    ds_read_b64_tr_b16 v[70:71], v11 offset:27136
    v_mfma_f32_16x16x32_bf16 a[0:3], v[12:15], v[84:87], a[0:3]
    v_mfma_f32_32x32x16_bf16 v[32:47], v[88:91], v[80:83], v[32:47]
    ds_read_b64_tr_b16 v[72:73], v11 offset:34816
    ds_read_b64_tr_b16 v[74:75], v11 offset:35328
    v_mfma_f32_16x16x32_bf16 a[4:7], v[12:15], v[88:91], a[4:7]
    v_mfma_f32_32x32x16_bf16 v[48:63], v[80:83], v[92:95], v[48:63]
    ds_read_b64_tr_b16 v[76:77], v11 offset:43008
    ds_read_b64_tr_b16 v[78:79], v11 offset:43520
    v_mfma_f32_16x16x32_bf16 a[8:11], v[12:15], v[92:95], a[8:11]
    s_waitcnt lgkmcnt(7)
    v_mfma_f32_32x32x16_bf16 v[16:31], v[100:103], v[96:99], v[16:31]
    s_barrier
    ds_read_b128 v[80:83], v4 offset:32768
    ds_read_b64_tr_b16 v[84:85], v8 offset:0
    ds_read_b64_tr_b16 v[86:87], v8 offset:512
    v_mfma_f32_32x32x16_bf16 v[32:47], v[104:107], v[96:99], v[32:47]
    ds_read_b64_tr_b16 v[88:89], v8 offset:8192
    ds_read_b64_tr_b16 v[90:91], v8 offset:8704
    v_mfma_f32_32x32x16_bf16 v[48:63], v[96:99], v[108:111], v[48:63]
    ds_read_b64_tr_b16 v[92:93], v8 offset:16384
    ds_read_b64_tr_b16 v[94:95], v8 offset:16896
    s_waitcnt lgkmcnt(7)
    v_mfma_f32_32x32x16_bf16 v[16:31], v[68:71], v[64:67], v[16:31]
    ds_read_b128 v[96:99], v5 offset:32768
    ds_read_b64_tr_b16 v[100:101], v8 offset:2048
    ds_read_b64_tr_b16 v[102:103], v8 offset:2560
    v_mfma_f32_32x32x16_bf16 v[32:47], v[72:75], v[64:67], v[32:47]
    ds_read_b64_tr_b16 v[104:105], v8 offset:10240
    ds_read_b64_tr_b16 v[106:107], v8 offset:10752
    v_mfma_f32_32x32x16_bf16 v[48:63], v[64:67], v[76:79], v[48:63]
    ds_read_b64_tr_b16 v[108:109], v8 offset:18432
    ds_read_b64_tr_b16 v[110:111], v8 offset:18944
    s_waitcnt lgkmcnt(7)
    v_mfma_f32_32x32x16_bf16 v[16:31], v[84:87], v[80:83], v[16:31]
    ds_read_b128 v[64:67], v6 offset:32768
    ds_read_b64_tr_b16 v[68:69], v9 offset:0
    ds_read_b64_tr_b16 v[70:71], v9 offset:512
    v_mfma_f32_16x16x32_bf16 a[0:3], v[12:15], v[84:87], a[0:3]
    v_mfma_f32_32x32x16_bf16 v[32:47], v[88:91], v[80:83], v[32:47]
    ds_read_b64_tr_b16 v[72:73], v9 offset:8192
    ds_read_b64_tr_b16 v[74:75], v9 offset:8704
    v_mfma_f32_16x16x32_bf16 a[4:7], v[12:15], v[88:91], a[4:7]
    v_mfma_f32_32x32x16_bf16 v[48:63], v[80:83], v[92:95], v[48:63]
    ds_read_b64_tr_b16 v[76:77], v9 offset:16384
    ds_read_b64_tr_b16 v[78:79], v9 offset:16896
    v_mfma_f32_16x16x32_bf16 a[8:11], v[12:15], v[92:95], a[8:11]
    s_waitcnt lgkmcnt(7)
    v_mfma_f32_32x32x16_bf16 v[16:31], v[100:103], v[96:99], v[16:31]
    ds_read_b128 v[80:83], v7 offset:32768
    ds_read_b64_tr_b16 v[84:85], v9 offset:2048
    ds_read_b64_tr_b16 v[86:87], v9 offset:2560
    v_mfma_f32_16x16x32_bf16 a[0:3], v[12:15], v[100:103], a[0:3]
    v_mfma_f32_32x32x16_bf16 v[32:47], v[104:107], v[96:99], v[32:47]
    ds_read_b64_tr_b16 v[88:89], v9 offset:10240
    ds_read_b64_tr_b16 v[90:91], v9 offset:10752
    v_mfma_f32_16x16x32_bf16 a[4:7], v[12:15], v[104:107], a[4:7]
    v_mfma_f32_32x32x16_bf16 v[48:63], v[96:99], v[108:111], v[48:63]
    ds_read_b64_tr_b16 v[92:93], v9 offset:18432
    ds_read_b64_tr_b16 v[94:95], v9 offset:18944
    v_mfma_f32_16x16x32_bf16 a[8:11], v[12:15], v[108:111], a[8:11]
    s_waitcnt lgkmcnt(7)
    v_mfma_f32_32x32x16_bf16 v[16:31], v[68:71], v[64:67], v[16:31]
    s_barrier
    ds_read_b128 v[96:99], v4 offset:40960
    ds_read_b64_tr_b16 v[100:101], v8 offset:24576
    ds_read_b64_tr_b16 v[102:103], v8 offset:25088
    v_mfma_f32_32x32x16_bf16 v[32:47], v[72:75], v[64:67], v[32:47]
    ds_read_b64_tr_b16 v[104:105], v8 offset:32768
    ds_read_b64_tr_b16 v[106:107], v8 offset:33280
    v_mfma_f32_32x32x16_bf16 v[48:63], v[64:67], v[76:79], v[48:63]
    ds_read_b64_tr_b16 v[108:109], v8 offset:40960
    ds_read_b64_tr_b16 v[110:111], v8 offset:41472
    s_waitcnt lgkmcnt(7)
    v_mfma_f32_32x32x16_bf16 v[16:31], v[84:87], v[80:83], v[16:31]
    ds_read_b128 v[64:67], v5 offset:40960
    ds_read_b64_tr_b16 v[68:69], v8 offset:26624
    ds_read_b64_tr_b16 v[70:71], v8 offset:27136
    v_mfma_f32_32x32x16_bf16 v[32:47], v[88:91], v[80:83], v[32:47]
    ds_read_b64_tr_b16 v[72:73], v8 offset:34816
    ds_read_b64_tr_b16 v[74:75], v8 offset:35328
    v_mfma_f32_32x32x16_bf16 v[48:63], v[80:83], v[92:95], v[48:63]
    ds_read_b64_tr_b16 v[76:77], v8 offset:43008
    ds_read_b64_tr_b16 v[78:79], v8 offset:43520
    s_waitcnt lgkmcnt(7)
    v_mfma_f32_32x32x16_bf16 v[16:31], v[100:103], v[96:99], v[16:31]
    ds_read_b128 v[80:83], v6 offset:40960
    ds_read_b64_tr_b16 v[84:85], v9 offset:24576
    ds_read_b64_tr_b16 v[86:87], v9 offset:25088
    v_mfma_f32_16x16x32_bf16 a[0:3], v[12:15], v[100:103], a[0:3]
    v_mfma_f32_32x32x16_bf16 v[32:47], v[104:107], v[96:99], v[32:47]
    ds_read_b64_tr_b16 v[88:89], v9 offset:32768
    ds_read_b64_tr_b16 v[90:91], v9 offset:33280
    v_mfma_f32_16x16x32_bf16 a[4:7], v[12:15], v[104:107], a[4:7]
    v_mfma_f32_32x32x16_bf16 v[48:63], v[96:99], v[108:111], v[48:63]
    ds_read_b64_tr_b16 v[92:93], v9 offset:40960
    ds_read_b64_tr_b16 v[94:95], v9 offset:41472
    v_mfma_f32_16x16x32_bf16 a[8:11], v[12:15], v[108:111], a[8:11]
    s_waitcnt lgkmcnt(7)
    v_mfma_f32_32x32x16_bf16 v[16:31], v[68:71], v[64:67], v[16:31]
    ds_read_b128 v[96:99], v7 offset:40960
    ds_read_b64_tr_b16 v[100:101], v9 offset:26624
    ds_read_b64_tr_b16 v[102:103], v9 offset:27136
    v_mfma_f32_16x16x32_bf16 a[0:3], v[12:15], v[68:71], a[0:3]
    v_mfma_f32_32x32x16_bf16 v[32:47], v[72:75], v[64:67], v[32:47]
    ds_read_b64_tr_b16 v[104:105], v9 offset:34816
    ds_read_b64_tr_b16 v[106:107], v9 offset:35328
    v_mfma_f32_16x16x32_bf16 a[4:7], v[12:15], v[72:75], a[4:7]
    v_mfma_f32_32x32x16_bf16 v[48:63], v[64:67], v[76:79], v[48:63]
    ds_read_b64_tr_b16 v[108:109], v9 offset:43008
    ds_read_b64_tr_b16 v[110:111], v9 offset:43520
    v_mfma_f32_16x16x32_bf16 a[8:11], v[12:15], v[76:79], a[8:11]
    s_waitcnt lgkmcnt(7)
    v_mfma_f32_32x32x16_bf16 v[16:31], v[84:87], v[80:83], v[16:31]
    s_barrier
    ds_read_b128 v[64:67], v4 offset:49152
    ds_read_b64_tr_b16 v[68:69], v10 offset:0
    ds_read_b64_tr_b16 v[70:71], v10 offset:512
    v_mfma_f32_32x32x16_bf16 v[32:47], v[88:91], v[80:83], v[32:47]
    ds_read_b64_tr_b16 v[72:73], v10 offset:8192
    ds_read_b64_tr_b16 v[74:75], v10 offset:8704
    v_mfma_f32_32x32x16_bf16 v[48:63], v[80:83], v[92:95], v[48:63]
    ds_read_b64_tr_b16 v[76:77], v10 offset:16384
    ds_read_b64_tr_b16 v[78:79], v10 offset:16896
    s_waitcnt lgkmcnt(7)
    v_mfma_f32_32x32x16_bf16 v[16:31], v[100:103], v[96:99], v[16:31]
    ds_read_b128 v[80:83], v5 offset:49152
    ds_read_b64_tr_b16 v[84:85], v10 offset:2048
    ds_read_b64_tr_b16 v[86:87], v10 offset:2560
    v_mfma_f32_32x32x16_bf16 v[32:47], v[104:107], v[96:99], v[32:47]
    ds_read_b64_tr_b16 v[88:89], v10 offset:10240
    ds_read_b64_tr_b16 v[90:91], v10 offset:10752
    v_mfma_f32_32x32x16_bf16 v[48:63], v[96:99], v[108:111], v[48:63]
    ds_read_b64_tr_b16 v[92:93], v10 offset:18432
    ds_read_b64_tr_b16 v[94:95], v10 offset:18944
    s_waitcnt lgkmcnt(7)
    v_mfma_f32_32x32x16_bf16 v[16:31], v[68:71], v[64:67], v[16:31]
    ds_read_b128 v[96:99], v6 offset:49152
    ds_read_b64_tr_b16 v[100:101], v11 offset:0
    ds_read_b64_tr_b16 v[102:103], v11 offset:512
    v_mfma_f32_16x16x32_bf16 a[0:3], v[12:15], v[68:71], a[0:3]
    v_mfma_f32_32x32x16_bf16 v[32:47], v[72:75], v[64:67], v[32:47]
    ds_read_b64_tr_b16 v[104:105], v11 offset:8192
    ds_read_b64_tr_b16 v[106:107], v11 offset:8704
    v_mfma_f32_16x16x32_bf16 a[4:7], v[12:15], v[72:75], a[4:7]
    v_mfma_f32_32x32x16_bf16 v[48:63], v[64:67], v[76:79], v[48:63]
    ds_read_b64_tr_b16 v[108:109], v11 offset:16384
    ds_read_b64_tr_b16 v[110:111], v11 offset:16896
    v_mfma_f32_16x16x32_bf16 a[8:11], v[12:15], v[76:79], a[8:11]
    s_waitcnt lgkmcnt(7)
    v_mfma_f32_32x32x16_bf16 v[16:31], v[84:87], v[80:83], v[16:31]
    ds_read_b128 v[64:67], v7 offset:49152
    ds_read_b64_tr_b16 v[68:69], v11 offset:2048
    ds_read_b64_tr_b16 v[70:71], v11 offset:2560
    v_mfma_f32_16x16x32_bf16 a[0:3], v[12:15], v[84:87], a[0:3]
    v_mfma_f32_32x32x16_bf16 v[32:47], v[88:91], v[80:83], v[32:47]
    ds_read_b64_tr_b16 v[72:73], v11 offset:10240
    ds_read_b64_tr_b16 v[74:75], v11 offset:10752
    v_mfma_f32_16x16x32_bf16 a[4:7], v[12:15], v[88:91], a[4:7]
    v_mfma_f32_32x32x16_bf16 v[48:63], v[80:83], v[92:95], v[48:63]
    ds_read_b64_tr_b16 v[76:77], v11 offset:18432
    ds_read_b64_tr_b16 v[78:79], v11 offset:18944
    v_mfma_f32_16x16x32_bf16 a[8:11], v[12:15], v[92:95], a[8:11]
    s_waitcnt lgkmcnt(7)
    v_mfma_f32_32x32x16_bf16 v[16:31], v[100:103], v[96:99], v[16:31]
    s_barrier
    ds_read_b128 v[80:83], v4 offset:57344
    ds_read_b64_tr_b16 v[84:85], v10 offset:24576
    ds_read_b64_tr_b16 v[86:87], v10 offset:25088
    v_mfma_f32_32x32x16_bf16 v[32:47], v[104:107], v[96:99], v[32:47]
    ds_read_b64_tr_b16 v[88:89], v10 offset:32768
    ds_read_b64_tr_b16 v[90:91], v10 offset:33280
    v_mfma_f32_32x32x16_bf16 v[48:63], v[96:99], v[108:111], v[48:63]
    ds_read_b64_tr_b16 v[92:93], v10 offset:40960
    ds_read_b64_tr_b16 v[94:95], v10 offset:41472
    s_waitcnt lgkmcnt(7)
    v_mfma_f32_32x32x16_bf16 v[16:31], v[68:71], v[64:67], v[16:31]
    ds_read_b128 v[96:99], v5 offset:57344
    ds_read_b64_tr_b16 v[100:101], v10 offset:26624
    ds_read_b64_tr_b16 v[102:103], v10 offset:27136
    v_mfma_f32_32x32x16_bf16 v[32:47], v[72:75], v[64:67], v[32:47]
    ds_read_b64_tr_b16 v[104:105], v10 offset:34816
    ds_read_b64_tr_b16 v[106:107], v10 offset:35328
    v_mfma_f32_32x32x16_bf16 v[48:63], v[64:67], v[76:79], v[48:63]
    ds_read_b64_tr_b16 v[108:109], v10 offset:43008
    ds_read_b64_tr_b16 v[110:111], v10 offset:43520
    s_waitcnt lgkmcnt(7)
    v_mfma_f32_32x32x16_bf16 v[16:31], v[84:87], v[80:83], v[16:31]
    ds_read_b128 v[64:67], v6 offset:57344
    ds_read_b64_tr_b16 v[68:69], v11 offset:24576
    ds_read_b64_tr_b16 v[70:71], v11 offset:25088
    v_mfma_f32_16x16x32_bf16 a[0:3], v[12:15], v[84:87], a[0:3]
    v_mfma_f32_32x32x16_bf16 v[32:47], v[88:91], v[80:83], v[32:47]
    ds_read_b64_tr_b16 v[72:73], v11 offset:32768
    ds_read_b64_tr_b16 v[74:75], v11 offset:33280
    v_mfma_f32_16x16x32_bf16 a[4:7], v[12:15], v[88:91], a[4:7]
    v_mfma_f32_32x32x16_bf16 v[48:63], v[80:83], v[92:95], v[48:63]
    ds_read_b64_tr_b16 v[76:77], v11 offset:40960
    ds_read_b64_tr_b16 v[78:79], v11 offset:41472
    v_mfma_f32_16x16x32_bf16 a[8:11], v[12:15], v[92:95], a[8:11]
    s_waitcnt lgkmcnt(7)
    v_mfma_f32_32x32x16_bf16 v[16:31], v[100:103], v[96:99], v[16:31]
    ds_read_b128 v[80:83], v7 offset:57344
    ds_read_b64_tr_b16 v[84:85], v11 offset:26624
    ds_read_b64_tr_b16 v[86:87], v11 offset:27136
    v_mfma_f32_16x16x32_bf16 a[0:3], v[12:15], v[100:103], a[0:3]
    v_mfma_f32_32x32x16_bf16 v[32:47], v[104:107], v[96:99], v[32:47]
    ds_read_b64_tr_b16 v[88:89], v11 offset:34816
    ds_read_b64_tr_b16 v[90:91], v11 offset:35328
    v_mfma_f32_16x16x32_bf16 a[4:7], v[12:15], v[104:107], a[4:7]
    v_mfma_f32_32x32x16_bf16 v[48:63], v[96:99], v[108:111], v[48:63]
    ds_read_b64_tr_b16 v[92:93], v11 offset:43008
    ds_read_b64_tr_b16 v[94:95], v11 offset:43520
    v_mfma_f32_16x16x32_bf16 a[8:11], v[12:15], v[108:111], a[8:11]
    s_waitcnt lgkmcnt(7)
    v_mfma_f32_32x32x16_bf16 v[16:31], v[68:71], v[64:67], v[16:31]
    s_nop 4
    v_accvgpr_read_b32 v12, a0
    v_accvgpr_read_b32 v13, a4
    v_accvgpr_read_b32 v14, a8
    ds_write_b128 v115, v[12:15]
    v_mfma_f32_32x32x16_bf16 v[32:47], v[72:75], v[64:67], v[32:47]
    s_waitcnt lgkmcnt(0)
    s_barrier
    ds_read_b128 v[120:123], v116
    ds_read_b32 v124, v117
    ds_read_b32 v126, v117 offset:256
    v_mfma_f32_32x32x16_bf16 v[48:63], v[64:67], v[76:79], v[48:63]
    v_mfma_f32_32x32x16_bf16 v[16:31], v[84:87], v[80:83], v[16:31]
    v_mov_b32 v98, 0
    v_mov_b32 v99, 0
    ds_read_b128 v[64:67], v118 offset:0
    ds_read_b128 v[68:71], v118 offset:32
    ds_read_b128 v[72:75], v118 offset:64
    ds_read_b128 v[76:79], v118 offset:96
    s_waitcnt lgkmcnt(4)
    v_add_f32 v12, v12, v120
    v_add_f32 v13, v13, v121
    v_add_f32 v14, v14, v122
    v_sub_f32 v15, 0, v124
    v_mfma_f32_32x32x16_bf16 v[32:47], v[88:91], v[80:83], v[32:47]
    v_cvt_pk_bf16_f32 v100, v12, v12
    v_cvt_pk_bf16_f32 v104, v13, v13
    v_cvt_pk_bf16_f32 v108, v14, v14
    v_cvt_pk_bf16_f32 v96, v15, v15
    v_and_b32 v120, 0xffff0000, v100
    v_and_b32 v121, 0xffff0000, v104
    v_and_b32 v122, 0xffff0000, v108
    v_and_b32 v123, 0xffff0000, v96
    v_mfma_f32_32x32x16_bf16 v[48:63], v[80:83], v[92:95], v[48:63]
    v_sub_f32 v12, v12, v120
    v_sub_f32 v13, v13, v121
    v_sub_f32 v14, v14, v122
    v_sub_f32 v15, v15, v123
    v_cvt_pk_bf16_f32 v97, v15, 0
    v_lshrrev_b32 v105, 16, v104
    v_cvt_pk_bf16_f32 v104, v121, v13
    v_lshrrev_b32 v109, 16, v108
    v_cvt_pk_bf16_f32 v108, v122, v14
    v_lshrrev_b32 v101, 16, v100
    v_cvt_pk_bf16_f32 v100, v120, v12
    v_mfma_f32_32x32x16_bf16 v[32:47], v[104:107], v[96:99], v[32:47]
    v_mfma_f32_32x32x16_bf16 v[48:63], v[96:99], v[108:111], v[48:63]
    v_mfma_f32_32x32x16_bf16 v[16:31], v[100:103], v[96:99], v[16:31]
    v_mul_f32 v124, 0x3eb8aa3b, v126
    s_waitcnt lgkmcnt(0)
    s_nop 7
    v_mul_f32 v32, v32, v126
    v_mul_f32 v33, v33, v126
    v_mul_f32 v34, v34, v126
    v_mul_f32 v35, v35, v126
    v_mul_f32 v36, v36, v126
    v_mul_f32 v37, v37, v126
    v_mul_f32 v38, v38, v126
    v_mul_f32 v39, v39, v126
    v_cvt_pk_bf16_f32 v80, v32, v33
    v_cvt_pk_bf16_f32 v81, v34, v35
    v_cvt_pk_bf16_f32 v82, v36, v37
    v_cvt_pk_bf16_f32 v83, v38, v39
    buffer_store_dwordx4 v[80:83], v113, s[40:43], s76 offen
    v_pk_mul_f32 v[40:41], v[40:41], v[126:127] op_sel_hi:[1,0]
    v_pk_mul_f32 v[42:43], v[42:43], v[126:127] op_sel_hi:[1,0]
    v_pk_mul_f32 v[44:45], v[44:45], v[126:127] op_sel_hi:[1,0]
    v_pk_mul_f32 v[46:47], v[46:47], v[126:127] op_sel_hi:[1,0]
    v_cvt_pk_bf16_f32 v84, v40, v41
    v_cvt_pk_bf16_f32 v85, v42, v43
    v_cvt_pk_bf16_f32 v86, v44, v45
    v_cvt_pk_bf16_f32 v87, v46, v47
    buffer_store_dwordx4 v[84:87], v113, s[40:43], s77 offen
    v_pk_mul_f32 v[48:49], v[48:49], v[64:65]
    v_pk_mul_f32 v[50:51], v[50:51], v[66:67]
    v_pk_mul_f32 v[52:53], v[52:53], v[68:69]
    v_pk_mul_f32 v[54:55], v[54:55], v[70:71]
    v_cvt_pk_bf16_f32 v88, v48, v49
    v_cvt_pk_bf16_f32 v89, v50, v51
    v_cvt_pk_bf16_f32 v90, v52, v53
    v_cvt_pk_bf16_f32 v91, v54, v55
    buffer_store_dwordx4 v[88:91], v114, s[40:43], s76 offen offset:1024
    v_pk_mul_f32 v[56:57], v[56:57], v[72:73]
    v_pk_mul_f32 v[58:59], v[58:59], v[74:75]
    v_pk_mul_f32 v[60:61], v[60:61], v[76:77]
    v_pk_mul_f32 v[62:63], v[62:63], v[78:79]
    v_cvt_pk_bf16_f32 v92, v56, v57
    v_cvt_pk_bf16_f32 v93, v58, v59
    v_cvt_pk_bf16_f32 v94, v60, v61
    v_cvt_pk_bf16_f32 v95, v62, v63
    buffer_store_dwordx4 v[92:95], v114, s[40:43], s76 offen offset:1536
    v_pk_mul_f32 v[16:17], v[16:17], v[124:125] op_sel_hi:[1,0]
    v_pk_mul_f32 v[18:19], v[18:19], v[124:125] op_sel_hi:[1,0]
    v_pk_mul_f32 v[20:21], v[20:21], v[124:125] op_sel_hi:[1,0]
    v_pk_mul_f32 v[22:23], v[22:23], v[124:125] op_sel_hi:[1,0]
    v_cvt_pk_bf16_f32 v96, v16, v17
    v_cvt_pk_bf16_f32 v97, v18, v19
    v_cvt_pk_bf16_f32 v98, v20, v21
    v_cvt_pk_bf16_f32 v99, v22, v23
    buffer_store_dwordx4 v[96:99], v112, s[40:43], s74 offen
    v_pk_mul_f32 v[24:25], v[24:25], v[124:125] op_sel_hi:[1,0]
    v_pk_mul_f32 v[26:27], v[26:27], v[124:125] op_sel_hi:[1,0]
    v_pk_mul_f32 v[28:29], v[28:29], v[124:125] op_sel_hi:[1,0]
    v_pk_mul_f32 v[30:31], v[30:31], v[124:125] op_sel_hi:[1,0]
    v_cvt_pk_bf16_f32 v100, v24, v25
    v_cvt_pk_bf16_f32 v101, v26, v27
    v_cvt_pk_bf16_f32 v102, v28, v29
    v_cvt_pk_bf16_f32 v103, v30, v31
    buffer_store_dwordx4 v[100:103], v112, s[40:43], s75 offen
P1_done:
    s_lshr_b32 s66, s3, 2
    s_mul_i32 s66, s66, 4160
    s_add_u32 s66, s66, 65536
    v_lshlrev_b32 v4, 4, v0
    v_add_u32 v1, s66, v4
    v_and_b32 v5, 15, v0
    v_lshrrev_b32 v110, 5, v0
    v_lshlrev_b32 v6, 8, v110
    v_lshl_add_u32 v5, v5, 4, v6
    v_add_u32 v2, 1024, v5
    v_add_u32 v3, 1536, v5
    v_and_b32 v5, 11, v0
    v_cmp_eq_u32 vcc, 0, v5
    v_mov_b32 v6, 2064
    v_mov_b32 v7, 2048
    v_cndmask_b32 v6, v6, v7, vcc
    v_and_b32 v5, 16, v0
    v_cmp_eq_u32 vcc, 0, v5
    v_mov_b32 v7, 0xdddddddd
    v_and_b32 v111, 31, v0
    v_cndmask_b32 v2, v6, v2, vcc
    v_cndmask_b32 v3, v6, v3, vcc
    v_add_u32 v2, s66, v2
    v_add_u32 v3, s66, v3
    v_lshlrev_b32 v111, 10, v111
    v_lshl_add_u32 v111, v110, 5, v111
    v_lshlrev_b32 v127, 7, v0
    v_lshrrev_b32 v125, 3, v0
    v_and_b32 v126, 2, v125
    v_lshlrev_b32 v125, 12, v125
    v_xor_b32 v126, v126, v0
    v_and_b32 v126, 7, v126
    v_lshl_add_u32 v125, v126, 4, v125
    s_lshl_b32 s66, s48, 7
    v_add_u32 v125, s66, v125
    v_xor_b32 v126, 64, v125
    v_add_u32 v126, 31744, v126
    s_cmp_ge_u32 s3, 4
    s_cbranch_scc1 F1_b0
    s_waitcnt vmcnt(0) lgkmcnt(0)
    s_barrier
F1_b0:
    v_lshrrev_b32 v110, 3, v0
    v_and_b32 v109, 7, v0
    v_and_b32 v5, 6, v110
    v_xor_b32 v5, v5, v109
    v_lshlrev_b32 v5, 4, v5
    v_mul_u32_u24 v6, 3584, v110
    s_mul_i32 s66, s81, 917504
    s_lshl_b32 s67, s50, 7
    s_add_u32 s66, s66, s67
    v_add3_u32 v5, v5, v6, s66
    v_add_u32 v6, 27648, v5
    v_lshrrev_b32 v104, 2, v0
    v_bfe_u32 v105, v0, 3, 2
    v_lshlrev_b32 v105, 5, v105
    v_lshl_add_u32 v104, v104, 7, v105
    v_and_b32 v105, 3, v0
    v_lshl_add_u32 v104, v105, 3, v104
    v_add_u32 v104, s57, v104
    v_xor_b32 v105, 32, v104
    v_xor_b32 v106, 64, v104
    v_xor_b32 v107, 96, v104
    v_bfe_u32 v108, v110, 1, 1
    v_lshlrev_b32 v108, 2, v108
    v_xor_b32 v108, v108, v109
    v_lshlrev_b32 v108, 4, v108
    v_lshl_add_u32 v108, v110, 10, v108
    s_lshl_b32 s66, s3, 13
    s_lshl_b32 s67, s49, 7
    s_add_u32 s66, s66, s67
    v_add_u32 v108, s66, v108
    s_mul_i32 s66, s3, 2304
    s_add_u32 s66, s66, 73856
    s_xor_b32 s67, s3, 4
    s_mul_i32 s67, s67, 2304
    s_add_u32 s67, s67, 73856
    v_add_u32 v120, s66, v4
    v_add_u32 v121, s67, v4
    v_lshl_add_u32 v122, v0, 2, s66
    v_lshl_add_u32 v123, v0, 2, s67
    v_mov_b32 v112, -1
    v_mov_b32 v113, -1
    v_mov_b32 v114, -1
    v_mov_b32 v115, -1
    v_mov_b32 v124, 1
    v_mov_b32 v110, 98296
    s_cmp_ge_u32 s45, 28
    s_cbranch_scc1 P2_idl
P2_idl_e:
    v_mov_b32 v48, 0
    v_mov_b32 v49, 0
    v_mov_b32 v50, 0
    v_mov_b32 v51, 0
    v_mov_b32 v52, 0
    v_mov_b32 v53, 0
    v_mov_b32 v54, 0
    v_mov_b32 v55, 0
    v_mov_b32 v56, 0
    v_mov_b32 v57, 0
    v_mov_b32 v58, 0
    v_mov_b32 v59, 0
    v_mov_b32 v60, 0
    v_mov_b32 v61, 0
    v_mov_b32 v62, 0
    v_mov_b32 v63, 0
    v_mov_b32 v64, 0
    v_mov_b32 v65, 0
    v_mov_b32 v66, 0
    v_mov_b32 v67, 0
    v_mov_b32 v68, 0
    v_mov_b32 v69, 0
    v_mov_b32 v70, 0
    v_mov_b32 v71, 0
    v_mov_b32 v72, 0
    v_mov_b32 v73, 0
    v_mov_b32 v74, 0
    v_mov_b32 v75, 0
    v_mov_b32 v76, 0
    v_mov_b32 v77, 0
    v_mov_b32 v78, 0
    v_mov_b32 v79, 0
    s_cmp_lt_u32 s3, 4
    s_cbranch_scc1 F1_join
    v_mov_b32 v18, s1
    v_lshlrev_b32 v19, 2, v0
    s_waitcnt vmcnt(0) lgkmcnt(0)
    s_barrier
    s_cmp_lg_u32 s3, 4
    s_cbranch_scc1 F1_skip
    s_mov_b64 exec, 1
    buffer_store_dword v18, off, s[40:43], s83
    ds_write_b32 v110, v124
    s_mov_b32 exec_lo, -1
    s_mov_b32 s67, 1
F1_p:
    buffer_load_dword v16, v19, s[40:43], s84 offen sc1
    s_waitcnt vmcnt(0) lgkmcnt(0)
    v_cmp_ne_u32 vcc, s1, v16
    s_cbranch_vccz F1_ok
    s_add_u32 s67, s67, 1
    s_and_b32 s66, s67, 15
    s_cbranch_scc1 F1_p
    s_branch F1_far
F1_skip:
    v_mov_b32 v16, 0x3f803f80
    v_mov_b32 v17, 0x3f803f80
    v_mov_b32 v18, 0x3f803f80
    v_mov_b32 v19, 0x3f803f80
    v_mov_b32 v24, 0
    v_mov_b32 v25, 0
    v_mov_b32 v26, 0
    v_mov_b32 v27, 0
    v_min_u32 v20, 11, v0
    v_mul_u32_u24 v20, 2080, v20
    v_add_u32 v20, 65536, v20
    ds_write_b128 v20, v[16:19] offset:2048
    ds_write_b128 v20, v[24:27] offset:2064
    s_waitcnt lgkmcnt(0)
F1_ok:
    s_mov_b64 exec, -1
F1_join:
    s_barrier
    s_add_u32 m0, s54, 0
    s_nop 0
    buffer_load_dwordx4 v4, s[40:43], s53 offen sc1 lds
    s_add_u32 s53, s53, 4096
    buffer_load_dwordx4 v[8:11], v4, s[40:43], s56 offen sc1
    buffer_load_dwordx4 v[12:15], v4, s[40:43], s55 offen sc1
    ds_read_b32 v110, v110
    s_waitcnt vmcnt(0) lgkmcnt(0)
    s_barrier
    ds_read_b128 v[80:83], v1 offset:0
    ds_read_b128 v[84:87], v2 offset:0
    ds_read_b128 v[88:91], v3 offset:0
    v_readfirstlane_b32 s0, v110
    s_add_u32 m0, s54, 8320
    s_nop 0
    buffer_load_dwordx4 v4, s[40:43], s53 offen sc1 lds
    s_add_u32 s53, s53, 4096
    s_waitcnt lgkmcnt(0)
    v_mfma_f32_32x32x16_bf16 v[16:31], v[80:83], v[8:11], 0
    s_add_u32 m0, s54, 16640
    s_nop 0
    buffer_load_dwordx4 v4, s[40:43], s53 offen sc1 lds
    s_add_u32 s53, s53, 4096
    s_add_u32 m0, s57, 0
    s_nop 0
    buffer_load_dwordx4 v5, s[16:19], s59 offen offset:0 lds
    buffer_load_dwordx4 v6, s[16:19], s59 offen offset:1024 lds
    s_add_u32 s59, s59, s79
    s_setprio 3
    s_nop 1
    v_exp_f32 v16, v16
    v_exp_f32 v17, v17
    ds_read_b128 v[92:95], v1 offset:2080
    ds_read_b128 v[96:99], v2 offset:2080
    ds_read_b128 v[100:103], v3 offset:2080
    v_exp_f32 v18, v18
    v_exp_f32 v19, v19
    v_exp_f32 v20, v20
    v_mfma_f32_32x32x16_bf16 v[32:47], v[80:83], v[12:15], 0
    v_exp_f32 v21, v21
    v_exp_f32 v22, v22
    v_exp_f32 v23, v23
    v_exp_f32 v24, v24
    v_exp_f32 v25, v25
    v_exp_f32 v26, v26
    s_add_u32 m0, s57, 2048
    v_smfmac_f32_32x32x32_bf16 v[48:63], v[84:87], v[16:23], v7
    buffer_load_dwordx4 v5, s[16:19], s59 offen offset:0 lds
    s_setprio 2
    v_exp_f32 v27, v27
    v_exp_f32 v28, v28
    v_exp_f32 v29, v29
    v_exp_f32 v30, v30
    v_exp_f32 v31, v31
    v_exp_f32 v32, v32
    v_exp_f32 v33, v33
    v_smfmac_f32_32x32x32_bf16 v[48:63], v[88:91], v[24:31], v7
    v_exp_f32 v34, v34
    v_exp_f32 v35, v35
    v_exp_f32 v36, v36
    s_waitcnt lgkmcnt(0)
    v_mfma_f32_32x32x16_bf16 v[16:31], v[92:95], v[8:11], 0
    s_setprio 1
    v_exp_f32 v37, v37
    v_exp_f32 v38, v38
    v_exp_f32 v39, v39
    v_exp_f32 v40, v40
    v_exp_f32 v41, v41
    v_exp_f32 v42, v42
    v_smfmac_f32_32x32x32_bf16 v[64:79], v[84:87], v[32:39], v7
    buffer_load_dwordx4 v6, s[16:19], s59 offen offset:1024 lds
    s_add_u32 s59, s59, s79
    s_setprio 0
    v_exp_f32 v43, v43
    v_exp_f32 v44, v44
    v_exp_f32 v45, v45
    v_exp_f32 v46, v46
    v_exp_f32 v47, v47
    v_exp_f32 v16, v16
    v_exp_f32 v17, v17
    v_smfmac_f32_32x32x32_bf16 v[64:79], v[88:91], v[40:47], v7
    s_setprio 3
    s_waitcnt vmcnt(5)
    s_barrier
    ds_read_b128 v[80:83], v1 offset:8320
    ds_read_b128 v[84:87], v2 offset:8320
    ds_read_b128 v[88:91], v3 offset:8320
    v_exp_f32 v18, v18
    v_exp_f32 v19, v19
    v_exp_f32 v20, v20
    v_mfma_f32_32x32x16_bf16 v[32:47], v[92:95], v[12:15], 0
    v_exp_f32 v21, v21
    v_exp_f32 v22, v22
    v_exp_f32 v23, v23
    v_exp_f32 v24, v24
    v_exp_f32 v25, v25
    v_exp_f32 v26, v26
    s_add_u32 m0, s54, 0
    v_smfmac_f32_32x32x32_bf16 v[48:63], v[96:99], v[16:23], v7
    buffer_load_dwordx4 v4, s[40:43], s53 offen sc1 lds
    s_add_u32 s53, s53, 4096
    v_exp_f32 v27, v27
    v_exp_f32 v28, v28
    v_exp_f32 v29, v29
    v_exp_f32 v30, v30
    v_exp_f32 v31, v31
    v_exp_f32 v32, v32
    v_exp_f32 v33, v33
    v_smfmac_f32_32x32x32_bf16 v[48:63], v[100:103], v[24:31], v7
    v_exp_f32 v34, v34
    v_exp_f32 v35, v35
    v_exp_f32 v36, v36
    s_waitcnt lgkmcnt(0)
    v_mfma_f32_32x32x16_bf16 v[16:31], v[80:83], v[8:11], 0
    v_exp_f32 v37, v37
    v_exp_f32 v38, v38
    v_exp_f32 v39, v39
    v_exp_f32 v40, v40
    v_exp_f32 v41, v41
    v_exp_f32 v42, v42
    v_smfmac_f32_32x32x32_bf16 v[64:79], v[96:99], v[32:39], v7
    buffer_store_dwordx4 v[112:115], v4, s[40:43], s61 offen offset:0 sc1
    v_exp_f32 v43, v43
    v_exp_f32 v44, v44
    v_exp_f32 v45, v45
    v_exp_f32 v46, v46
    v_exp_f32 v47, v47
    v_exp_f32 v16, v16
    v_exp_f32 v17, v17
    v_smfmac_f32_32x32x32_bf16 v[64:79], v[100:103], v[40:47], v7
    ds_read_b128 v[92:95], v1 offset:10400
    ds_read_b128 v[96:99], v2 offset:10400
    ds_read_b128 v[100:103], v3 offset:10400
    v_exp_f32 v18, v18
    v_exp_f32 v19, v19
    v_exp_f32 v20, v20
    v_mfma_f32_32x32x16_bf16 v[32:47], v[80:83], v[12:15], 0
    v_exp_f32 v21, v21
    v_exp_f32 v22, v22
    v_exp_f32 v23, v23
    v_exp_f32 v24, v24
    v_exp_f32 v25, v25
    v_exp_f32 v26, v26
    v_smfmac_f32_32x32x32_bf16 v[48:63], v[84:87], v[16:23], v7
    s_setprio 2
    v_exp_f32 v27, v27
    v_exp_f32 v28, v28
    v_exp_f32 v29, v29
    v_exp_f32 v30, v30
    v_exp_f32 v31, v31
    v_exp_f32 v32, v32
    v_exp_f32 v33, v33
    v_smfmac_f32_32x32x32_bf16 v[48:63], v[88:91], v[24:31], v7
    v_exp_f32 v34, v34
    v_exp_f32 v35, v35
    v_exp_f32 v36, v36
    s_waitcnt vmcnt(6) lgkmcnt(0)
    v_mfma_f32_32x32x16_bf16 v[16:31], v[92:95], v[8:11], 0
    s_setprio 1
    v_exp_f32 v37, v37
    v_exp_f32 v38, v38
    v_exp_f32 v39, v39
    v_exp_f32 v40, v40
    v_exp_f32 v41, v41
    v_exp_f32 v42, v42
    s_add_u32 m0, s57, 32768
    v_smfmac_f32_32x32x32_bf16 v[64:79], v[84:87], v[32:39], v7
    buffer_load_dwordx4 v5, s[16:19], s59 offen offset:0 lds
    s_setprio 0
    v_exp_f32 v43, v43
    v_exp_f32 v44, v44
    v_exp_f32 v45, v45
    v_exp_f32 v46, v46
    v_exp_f32 v47, v47
    v_exp_f32 v16, v16
    v_exp_f32 v17, v17
    v_smfmac_f32_32x32x32_bf16 v[64:79], v[88:91], v[40:47], v7
    s_setprio 3
    s_barrier
    ds_read_b128 v[80:83], v1 offset:16640
    ds_read_b128 v[84:87], v2 offset:16640
    ds_read_b128 v[88:91], v3 offset:16640
    v_exp_f32 v18, v18
    v_exp_f32 v19, v19
    v_exp_f32 v20, v20
    v_mfma_f32_32x32x16_bf16 v[32:47], v[92:95], v[12:15], 0
    v_exp_f32 v21, v21
    v_exp_f32 v22, v22
    v_exp_f32 v23, v23
    v_exp_f32 v24, v24
    v_exp_f32 v25, v25
    v_exp_f32 v26, v26
    s_add_u32 m0, s54, 8320
    v_smfmac_f32_32x32x32_bf16 v[48:63], v[96:99], v[16:23], v7
    buffer_load_dwordx4 v4, s[40:43], s53 offen sc1 lds
    s_add_u32 s53, s53, 4096
    v_exp_f32 v27, v27
    v_exp_f32 v28, v28
    v_exp_f32 v29, v29
    v_exp_f32 v30, v30
    v_exp_f32 v31, v31
    v_exp_f32 v32, v32
    v_exp_f32 v33, v33
    v_smfmac_f32_32x32x32_bf16 v[48:63], v[100:103], v[24:31], v7
    v_exp_f32 v34, v34
    v_exp_f32 v35, v35
    v_exp_f32 v36, v36
    s_waitcnt lgkmcnt(0)
    v_mfma_f32_32x32x16_bf16 v[16:31], v[80:83], v[8:11], 0
    v_exp_f32 v37, v37
    v_exp_f32 v38, v38
    v_exp_f32 v39, v39
    v_exp_f32 v40, v40
    v_exp_f32 v41, v41
    v_exp_f32 v42, v42
    v_smfmac_f32_32x32x32_bf16 v[64:79], v[96:99], v[32:39], v7
    buffer_store_dwordx4 v[112:115], v4, s[40:43], s61 offen offset:1024 sc1
    v_exp_f32 v43, v43
    v_exp_f32 v44, v44
    v_exp_f32 v45, v45
    v_exp_f32 v46, v46
    v_exp_f32 v47, v47
    v_exp_f32 v16, v16
    v_exp_f32 v17, v17
    v_smfmac_f32_32x32x32_bf16 v[64:79], v[100:103], v[40:47], v7
    ds_read_b128 v[92:95], v1 offset:18720
    ds_read_b128 v[96:99], v2 offset:18720
    ds_read_b128 v[100:103], v3 offset:18720
    v_exp_f32 v18, v18
    v_exp_f32 v19, v19
    v_exp_f32 v20, v20
    v_mfma_f32_32x32x16_bf16 v[32:47], v[80:83], v[12:15], 0
    v_exp_f32 v21, v21
    v_exp_f32 v22, v22
    v_exp_f32 v23, v23
    v_exp_f32 v24, v24
    v_exp_f32 v25, v25
    v_exp_f32 v26, v26
    v_smfmac_f32_32x32x32_bf16 v[48:63], v[84:87], v[16:23], v7
    s_setprio 2
    v_exp_f32 v27, v27
    v_exp_f32 v28, v28
    v_exp_f32 v29, v29
    v_exp_f32 v30, v30
    v_exp_f32 v31, v31
    v_exp_f32 v32, v32
    v_exp_f32 v33, v33
    v_smfmac_f32_32x32x32_bf16 v[48:63], v[88:91], v[24:31], v7
    v_exp_f32 v34, v34
    v_exp_f32 v35, v35
    v_exp_f32 v36, v36
    s_waitcnt vmcnt(4) lgkmcnt(0)
    v_mfma_f32_32x32x16_bf16 v[16:31], v[92:95], v[8:11], 0
    s_setprio 1
    v_exp_f32 v37, v37
    v_exp_f32 v38, v38
    v_exp_f32 v39, v39
    v_exp_f32 v40, v40
    v_exp_f32 v41, v41
    v_exp_f32 v42, v42
    s_add_u32 m0, s57, 32768
    v_smfmac_f32_32x32x32_bf16 v[64:79], v[84:87], v[32:39], v7
    buffer_load_dwordx4 v6, s[16:19], s59 offen offset:1024 lds
    s_add_u32 s59, s59, s79
    s_setprio 0
    v_exp_f32 v43, v43
    v_exp_f32 v44, v44
    v_exp_f32 v45, v45
    v_exp_f32 v46, v46
    v_exp_f32 v47, v47
    v_exp_f32 v16, v16
    v_exp_f32 v17, v17
    v_smfmac_f32_32x32x32_bf16 v[64:79], v[88:91], v[40:47], v7
    s_setprio 3
    s_barrier
    ds_read_b128 v[80:83], v1 offset:0
    ds_read_b128 v[84:87], v2 offset:0
    ds_read_b128 v[88:91], v3 offset:0
    v_exp_f32 v18, v18
    v_exp_f32 v19, v19
    v_exp_f32 v20, v20
    v_mfma_f32_32x32x16_bf16 v[32:47], v[92:95], v[12:15], 0
    v_exp_f32 v21, v21
    v_exp_f32 v22, v22
    v_exp_f32 v23, v23
    v_exp_f32 v24, v24
    v_exp_f32 v25, v25
    v_exp_f32 v26, v26
    s_add_u32 m0, s54, 16640
    v_smfmac_f32_32x32x32_bf16 v[48:63], v[96:99], v[16:23], v7
    buffer_load_dwordx4 v4, s[40:43], s53 offen sc1 lds
    s_add_u32 s53, s53, 4096
    v_exp_f32 v27, v27
    v_exp_f32 v28, v28
    v_exp_f32 v29, v29
    v_exp_f32 v30, v30
    v_exp_f32 v31, v31
    v_exp_f32 v32, v32
    v_exp_f32 v33, v33
    v_smfmac_f32_32x32x32_bf16 v[48:63], v[100:103], v[24:31], v7
    v_exp_f32 v34, v34
    v_exp_f32 v35, v35
    v_exp_f32 v36, v36
    s_waitcnt lgkmcnt(0)
    v_mfma_f32_32x32x16_bf16 v[16:31], v[80:83], v[8:11], 0
    v_exp_f32 v37, v37
    v_exp_f32 v38, v38
    v_exp_f32 v39, v39
    v_exp_f32 v40, v40
    v_exp_f32 v41, v41
    v_exp_f32 v42, v42
    v_smfmac_f32_32x32x32_bf16 v[64:79], v[96:99], v[32:39], v7
    buffer_store_dwordx4 v[112:115], v4, s[40:43], s61 offen offset:2048 sc1
    v_exp_f32 v43, v43
    v_exp_f32 v44, v44
    v_exp_f32 v45, v45
    v_exp_f32 v46, v46
    v_exp_f32 v47, v47
    v_exp_f32 v16, v16
    v_exp_f32 v17, v17
    v_smfmac_f32_32x32x32_bf16 v[64:79], v[100:103], v[40:47], v7
    ds_read_b128 v[92:95], v1 offset:2080
    ds_read_b128 v[96:99], v2 offset:2080
    ds_read_b128 v[100:103], v3 offset:2080
    v_exp_f32 v18, v18
    v_exp_f32 v19, v19
    v_exp_f32 v20, v20
    v_mfma_f32_32x32x16_bf16 v[32:47], v[80:83], v[12:15], 0
    v_exp_f32 v21, v21
    v_exp_f32 v22, v22
    v_exp_f32 v23, v23
    v_exp_f32 v24, v24
    v_exp_f32 v25, v25
    v_exp_f32 v26, v26
    v_smfmac_f32_32x32x32_bf16 v[48:63], v[84:87], v[16:23], v7
    s_setprio 2
    v_exp_f32 v27, v27
    v_exp_f32 v28, v28
    v_exp_f32 v29, v29
    v_exp_f32 v30, v30
    v_exp_f32 v31, v31
    v_exp_f32 v32, v32
    v_exp_f32 v33, v33
    v_smfmac_f32_32x32x32_bf16 v[48:63], v[88:91], v[24:31], v7
    v_exp_f32 v34, v34
    v_exp_f32 v35, v35
    v_exp_f32 v36, v36
    s_waitcnt vmcnt(4) lgkmcnt(0)
    v_mfma_f32_32x32x16_bf16 v[16:31], v[92:95], v[8:11], 0
    s_setprio 1
    ds_read_b64_tr_b16 a[0:1], v104 offset:0
    ds_read_b64_tr_b16 a[4:5], v105 offset:0
    ds_read_b64_tr_b16 a[8:9], v106 offset:0
    ds_read_b64_tr_b16 a[12:13], v107 offset:0
    v_exp_f32 v37, v37
    v_exp_f32 v38, v38
    v_exp_f32 v39, v39
    v_exp_f32 v40, v40
    v_exp_f32 v41, v41
    v_exp_f32 v42, v42
    s_add_u32 m0, s57, 34816
    v_smfmac_f32_32x32x32_bf16 v[64:79], v[84:87], v[32:39], v7
    buffer_load_dwordx4 v5, s[16:19], s59 offen offset:0 lds
    s_setprio 0
    v_exp_f32 v43, v43
    v_exp_f32 v44, v44
    v_exp_f32 v45, v45
    v_exp_f32 v46, v46
    v_exp_f32 v47, v47
    v_exp_f32 v16, v16
    v_exp_f32 v17, v17
    v_smfmac_f32_32x32x32_bf16 v[64:79], v[88:91], v[40:47], v7
    s_setprio 3
    s_barrier
    ds_read_b128 v[80:83], v1 offset:8320
    ds_read_b128 v[84:87], v2 offset:8320
    ds_read_b128 v[88:91], v3 offset:8320
    v_exp_f32 v18, v18
    v_exp_f32 v19, v19
    v_exp_f32 v20, v20
    v_mfma_f32_32x32x16_bf16 v[32:47], v[92:95], v[12:15], 0
    v_exp_f32 v21, v21
    v_exp_f32 v22, v22
    v_exp_f32 v23, v23
    v_exp_f32 v24, v24
    v_exp_f32 v25, v25
    v_exp_f32 v26, v26
    s_add_u32 m0, s54, 0
    v_smfmac_f32_32x32x32_bf16 v[48:63], v[96:99], v[16:23], v7
    buffer_load_dwordx4 v4, s[40:43], s53 offen sc1 lds
    s_add_u32 s53, s53, 4096
    v_exp_f32 v27, v27
    v_exp_f32 v28, v28
    v_exp_f32 v29, v29
    v_exp_f32 v30, v30
    v_exp_f32 v31, v31
    v_exp_f32 v32, v32
    v_exp_f32 v33, v33
    v_smfmac_f32_32x32x32_bf16 v[48:63], v[100:103], v[24:31], v7
    v_exp_f32 v34, v34
    v_exp_f32 v35, v35
    v_exp_f32 v36, v36
    s_waitcnt lgkmcnt(0)
    v_mfma_f32_32x32x16_bf16 v[16:31], v[80:83], v[8:11], 0
    v_exp_f32 v37, v37
    v_exp_f32 v38, v38
    v_exp_f32 v39, v39
    v_exp_f32 v40, v40
    v_exp_f32 v41, v41
    v_exp_f32 v42, v42
    s_add_u32 m0, s57, 34816
    v_smfmac_f32_32x32x32_bf16 v[64:79], v[96:99], v[32:39], v7
    buffer_load_dwordx4 v6, s[16:19], s59 offen offset:1024 lds
    s_add_u32 s59, s59, s79
    v_exp_f32 v43, v43
    v_exp_f32 v44, v44
    v_exp_f32 v45, v45
    v_exp_f32 v46, v46
    v_exp_f32 v47, v47
    v_exp_f32 v16, v16
    v_exp_f32 v17, v17
    v_smfmac_f32_32x32x32_bf16 v[64:79], v[100:103], v[40:47], v7
    ds_read_b128 v[92:95], v1 offset:10400
    ds_read_b128 v[96:99], v2 offset:10400
    ds_read_b128 v[100:103], v3 offset:10400
    v_exp_f32 v18, v18
    v_exp_f32 v19, v19
    v_exp_f32 v20, v20
    v_mfma_f32_32x32x16_bf16 v[32:47], v[80:83], v[12:15], 0
    v_exp_f32 v21, v21
    v_exp_f32 v22, v22
    v_exp_f32 v23, v23
    v_exp_f32 v24, v24
    v_exp_f32 v25, v25
    v_exp_f32 v26, v26
    s_add_u32 m0, s57, 0
    v_smfmac_f32_32x32x32_bf16 v[48:63], v[84:87], v[16:23], v7
    buffer_load_dwordx4 v5, s[16:19], s59 offen offset:0 lds
    s_setprio 2
    v_exp_f32 v27, v27
    v_exp_f32 v28, v28
    v_exp_f32 v29, v29
    v_exp_f32 v30, v30
    v_exp_f32 v31, v31
    v_exp_f32 v32, v32
    v_exp_f32 v33, v33
    v_smfmac_f32_32x32x32_bf16 v[48:63], v[88:91], v[24:31], v7
    v_exp_f32 v34, v34
    v_exp_f32 v35, v35
    v_exp_f32 v36, v36
    s_waitcnt vmcnt(5) lgkmcnt(0)
    v_mfma_f32_32x32x16_bf16 v[16:31], v[92:95], v[8:11], 0
    s_setprio 1
    ds_read_b64_tr_b16 a[2:3], v104 offset:2048
    ds_read_b64_tr_b16 a[6:7], v105 offset:2048
    ds_read_b64_tr_b16 a[10:11], v106 offset:2048
    ds_read_b64_tr_b16 a[14:15], v107 offset:2048
    v_exp_f32 v37, v37
    v_exp_f32 v38, v38
    v_exp_f32 v39, v39
    v_exp_f32 v40, v40
    v_exp_f32 v41, v41
    v_exp_f32 v42, v42
    v_smfmac_f32_32x32x32_bf16 v[64:79], v[84:87], v[32:39], v7
    buffer_load_dwordx4 v6, s[16:19], s59 offen offset:1024 lds
    s_add_u32 s59, s59, s79
    s_setprio 0
    v_exp_f32 v43, v43
    v_exp_f32 v44, v44
    v_exp_f32 v45, v45
    v_exp_f32 v46, v46
    v_exp_f32 v47, v47
    v_exp_f32 v16, v16
    v_exp_f32 v17, v17
    v_smfmac_f32_32x32x32_bf16 v[64:79], v[88:91], v[40:47], v7
    s_setprio 3
    s_barrier
    ds_read_b128 v[80:83], v1 offset:16640
    ds_read_b128 v[84:87], v2 offset:16640
    ds_read_b128 v[88:91], v3 offset:16640
    v_exp_f32 v18, v18
    v_exp_f32 v19, v19
    v_exp_f32 v20, v20
    v_mfma_f32_32x32x16_bf16 v[32:47], v[92:95], v[12:15], 0
    v_exp_f32 v21, v21
    v_exp_f32 v22, v22
    v_exp_f32 v23, v23
    v_exp_f32 v24, v24
    v_exp_f32 v25, v25
    v_exp_f32 v26, v26
    s_add_u32 m0, s54, 8320
    v_smfmac_f32_32x32x32_bf16 v[48:63], v[96:99], v[16:23], v7
    buffer_load_dwordx4 v4, s[40:43], s53 offen sc1 lds
    s_add_u32 s53, s53, 4096
    v_exp_f32 v27, v27
    v_exp_f32 v28, v28
    v_exp_f32 v29, v29
    v_exp_f32 v30, v30
    v_exp_f32 v31, v31
    v_exp_f32 v32, v32
    v_exp_f32 v33, v33
    v_smfmac_f32_32x32x32_bf16 v[48:63], v[100:103], v[24:31], v7
    v_exp_f32 v34, v34
    v_exp_f32 v35, v35
    v_exp_f32 v36, v36
    s_waitcnt lgkmcnt(0)
    v_mfma_f32_32x32x16_bf16 v[16:31], v[80:83], v[8:11], 0
    v_exp_f32 v37, v37
    v_exp_f32 v38, v38
    v_exp_f32 v39, v39
    v_exp_f32 v40, v40
    v_exp_f32 v41, v41
    v_exp_f32 v42, v42
    s_add_u32 m0, s58, 0
    s_mov_b32 s66, 0x10000
    v_smfmac_f32_32x32x32_bf16 v[64:79], v[96:99], v[32:39], v7
    buffer_load_dwordx4 v108, s[12:15], s66 offen lds
    v_exp_f32 v43, v43
    v_exp_f32 v44, v44
    v_exp_f32 v45, v45
    v_exp_f32 v46, v46
    v_exp_f32 v47, v47
    v_exp_f32 v16, v16
    v_exp_f32 v17, v17
    v_smfmac_f32_32x32x32_bf16 v[64:79], v[100:103], v[40:47], v7
    ds_read_b128 v[92:95], v1 offset:18720
    ds_read_b128 v[96:99], v2 offset:18720
    ds_read_b128 v[100:103], v3 offset:18720
    v_exp_f32 v18, v18
    v_exp_f32 v19, v19
    v_exp_f32 v20, v20
    v_mfma_f32_32x32x16_bf16 v[32:47], v[80:83], v[12:15], 0
    v_exp_f32 v21, v21
    v_exp_f32 v22, v22
    v_exp_f32 v23, v23
    v_exp_f32 v24, v24
    v_exp_f32 v25, v25
    v_exp_f32 v26, v26
    s_add_u32 m0, s57, 2048
    v_smfmac_f32_32x32x32_bf16 v[48:63], v[84:87], v[16:23], v7
    buffer_load_dwordx4 v5, s[16:19], s59 offen offset:0 lds
    s_setprio 2
    v_exp_f32 v27, v27
    v_exp_f32 v28, v28
    v_exp_f32 v29, v29
    v_exp_f32 v30, v30
    v_exp_f32 v31, v31
    v_exp_f32 v32, v32
    v_exp_f32 v33, v33
    v_smfmac_f32_32x32x32_bf16 v[48:63], v[88:91], v[24:31], v7
    v_exp_f32 v34, v34
    v_exp_f32 v35, v35
    v_exp_f32 v36, v36
    s_waitcnt vmcnt(6) lgkmcnt(0)
    v_mfma_f32_32x32x16_bf16 v[16:31], v[92:95], v[8:11], 0
    s_setprio 1
    ds_read_b64_tr_b16 a[16:17], v104 offset:32768
    ds_read_b64_tr_b16 a[20:21], v105 offset:32768
    ds_read_b64_tr_b16 a[24:25], v106 offset:32768
    ds_read_b64_tr_b16 a[28:29], v107 offset:32768
    v_exp_f32 v37, v37
    v_exp_f32 v38, v38
    v_exp_f32 v39, v39
    v_exp_f32 v40, v40
    v_exp_f32 v41, v41
    v_exp_f32 v42, v42
    v_smfmac_f32_32x32x32_bf16 v[64:79], v[84:87], v[32:39], v7
    buffer_load_dwordx4 v6, s[16:19], s59 offen offset:1024 lds
    s_add_u32 s59, s59, s79
    s_setprio 0
    v_exp_f32 v43, v43
    v_exp_f32 v44, v44
    v_exp_f32 v45, v45
    v_exp_f32 v46, v46
    v_exp_f32 v47, v47
    v_exp_f32 v16, v16
    v_exp_f32 v17, v17
    v_smfmac_f32_32x32x32_bf16 v[64:79], v[88:91], v[40:47], v7
    s_setprio 3
    s_barrier
    ds_read_b128 v[80:83], v1 offset:0
    ds_read_b128 v[84:87], v2 offset:0
    ds_read_b128 v[88:91], v3 offset:0
    v_exp_f32 v18, v18
    v_exp_f32 v19, v19
    v_exp_f32 v20, v20
    v_mfma_f32_32x32x16_bf16 v[32:47], v[92:95], v[12:15], 0
    v_exp_f32 v21, v21
    v_exp_f32 v22, v22
    v_exp_f32 v23, v23
    v_exp_f32 v24, v24
    v_exp_f32 v25, v25
    v_exp_f32 v26, v26
    s_add_u32 m0, s54, 16640
    v_smfmac_f32_32x32x32_bf16 v[48:63], v[96:99], v[16:23], v7
    buffer_load_dwordx4 v4, s[40:43], s53 offen sc1 lds
    s_add_u32 s53, s53, 4096
    v_exp_f32 v27, v27
    v_exp_f32 v28, v28
    v_exp_f32 v29, v29
    v_exp_f32 v30, v30
    v_exp_f32 v31, v31
    v_exp_f32 v32, v32
    v_exp_f32 v33, v33
    v_smfmac_f32_32x32x32_bf16 v[48:63], v[100:103], v[24:31], v7
    v_exp_f32 v34, v34
    v_exp_f32 v35, v35
    v_exp_f32 v36, v36
    s_waitcnt vmcnt(7) lgkmcnt(0)
    v_mfma_f32_32x32x16_bf16 v[16:31], v[80:83], v[8:11], 0
    ds_read_b64_tr_b16 a[18:19], v104 offset:34816
    ds_read_b64_tr_b16 a[22:23], v105 offset:34816
    ds_read_b64_tr_b16 a[26:27], v106 offset:34816
    ds_read_b64_tr_b16 a[30:31], v107 offset:34816
    v_exp_f32 v37, v37
    buffer_store_dword v124, off, s[40:43], s62 sc1
    v_exp_f32 v38, v38
    v_exp_f32 v39, v39
    v_exp_f32 v40, v40
    v_exp_f32 v41, v41
    v_exp_f32 v42, v42
    s_add_u32 m0, s57, 32768
    v_smfmac_f32_32x32x32_bf16 v[64:79], v[96:99], v[32:39], v7
    buffer_load_dwordx4 v5, s[16:19], s59 offen offset:0 lds
    v_exp_f32 v43, v43
    v_exp_f32 v44, v44
    v_exp_f32 v45, v45
    v_exp_f32 v46, v46
    v_exp_f32 v47, v47
    v_exp_f32 v16, v16
    v_exp_f32 v17, v17
    v_smfmac_f32_32x32x32_bf16 v[64:79], v[100:103], v[40:47], v7
    ds_read_b128 v[92:95], v1 offset:2080
    ds_read_b128 v[96:99], v2 offset:2080
    ds_read_b128 v[100:103], v3 offset:2080
    v_exp_f32 v18, v18
    v_exp_f32 v19, v19
    v_exp_f32 v20, v20
    v_mfma_f32_32x32x16_bf16 v[32:47], v[80:83], v[12:15], 0
    v_exp_f32 v21, v21
    v_exp_f32 v22, v22
    v_exp_f32 v23, v23
    v_exp_f32 v24, v24
    v_exp_f32 v25, v25
    v_exp_f32 v26, v26
    v_smfmac_f32_32x32x32_bf16 v[48:63], v[84:87], v[16:23], v7
    buffer_load_dwordx4 v6, s[16:19], s59 offen offset:1024 lds
    s_add_u32 s59, s59, s79
    s_setprio 2
    v_exp_f32 v27, v27
    v_exp_f32 v28, v28
    v_exp_f32 v29, v29
    v_exp_f32 v30, v30
    v_exp_f32 v31, v31
    v_exp_f32 v32, v32
    v_exp_f32 v33, v33
    v_smfmac_f32_32x32x32_bf16 v[48:63], v[88:91], v[24:31], v7
    v_exp_f32 v34, v34
    v_exp_f32 v35, v35
    v_exp_f32 v36, v36
    s_waitcnt vmcnt(7) lgkmcnt(0)
    v_mfma_f32_32x32x16_bf16 v[16:31], v[92:95], v[8:11], 0
    s_setprio 1
    v_exp_f32 v37, v37
    v_exp_f32 v38, v38
    v_exp_f32 v39, v39
    v_exp_f32 v40, v40
    v_exp_f32 v41, v41
    v_exp_f32 v42, v42
    s_add_u32 m0, s57, 34816
    v_smfmac_f32_32x32x32_bf16 v[64:79], v[84:87], v[32:39], v7
    buffer_load_dwordx4 v5, s[16:19], s59 offen offset:0 lds
    s_setprio 0
    v_exp_f32 v43, v43
    v_exp_f32 v44, v44
    v_exp_f32 v45, v45
    v_exp_f32 v46, v46
    v_exp_f32 v47, v47
    v_exp_f32 v16, v16
    v_exp_f32 v17, v17
    v_smfmac_f32_32x32x32_bf16 v[64:79], v[88:91], v[40:47], v7
    s_setprio 3
    s_barrier
    ds_read_b128 v[80:83], v1 offset:8320
    ds_read_b128 v[84:87], v2 offset:8320
    ds_read_b128 v[88:91], v3 offset:8320
    v_exp_f32 v18, v18
    v_exp_f32 v19, v19
    v_exp_f32 v20, v20
    v_mfma_f32_32x32x16_bf16 v[32:47], v[92:95], v[12:15], 0
    v_exp_f32 v21, v21
    v_exp_f32 v22, v22
    v_exp_f32 v23, v23
    v_exp_f32 v24, v24
    v_exp_f32 v25, v25
    v_exp_f32 v26, v26
    s_add_u32 m0, s54, 0
    v_smfmac_f32_32x32x32_bf16 v[48:63], v[96:99], v[16:23], v7
    buffer_load_dwordx4 v4, s[40:43], s53 offen sc1 lds
    s_add_u32 s53, s53, 4096
    v_exp_f32 v27, v27
    v_exp_f32 v28, v28
    v_exp_f32 v29, v29
    v_exp_f32 v30, v30
    v_exp_f32 v31, v31
    v_exp_f32 v32, v32
    v_exp_f32 v33, v33
    v_smfmac_f32_32x32x32_bf16 v[48:63], v[100:103], v[24:31], v7
    v_exp_f32 v34, v34
    v_exp_f32 v35, v35
    v_exp_f32 v36, v36
    s_waitcnt lgkmcnt(0)
    v_mfma_f32_32x32x16_bf16 v[16:31], v[80:83], v[8:11], 0
    ds_read_b64_tr_b16 a[32:33], v104 offset:0
    ds_read_b64_tr_b16 a[36:37], v105 offset:0
    ds_read_b64_tr_b16 a[40:41], v106 offset:0
    ds_read_b64_tr_b16 a[44:45], v107 offset:0
    v_exp_f32 v37, v37
    v_exp_f32 v38, v38
    v_exp_f32 v39, v39
    v_exp_f32 v40, v40
    v_exp_f32 v41, v41
    v_exp_f32 v42, v42
    s_add_u32 m0, s58, 8192
    s_mov_b32 s66, 0x70000
    v_smfmac_f32_32x32x32_bf16 v[64:79], v[96:99], v[32:39], v7
    buffer_load_dwordx4 v108, s[12:15], s66 offen lds
    v_exp_f32 v43, v43
    v_exp_f32 v44, v44
    v_exp_f32 v45, v45
    v_exp_f32 v46, v46
    v_exp_f32 v47, v47
    v_exp_f32 v16, v16
    v_exp_f32 v17, v17
    v_smfmac_f32_32x32x32_bf16 v[64:79], v[100:103], v[40:47], v7
    ds_read_b128 v[92:95], v1 offset:10400
    ds_read_b128 v[96:99], v2 offset:10400
    ds_read_b128 v[100:103], v3 offset:10400
    v_exp_f32 v18, v18
    v_exp_f32 v19, v19
    v_exp_f32 v20, v20
    v_mfma_f32_32x32x16_bf16 v[32:47], v[80:83], v[12:15], 0
    v_exp_f32 v21, v21
    v_exp_f32 v22, v22
    v_exp_f32 v23, v23
    v_exp_f32 v24, v24
    v_exp_f32 v25, v25
    v_exp_f32 v26, v26
    s_add_u32 m0, s57, 34816
    v_smfmac_f32_32x32x32_bf16 v[48:63], v[84:87], v[16:23], v7
    buffer_load_dwordx4 v6, s[16:19], s59 offen offset:1024 lds
    s_add_u32 s59, s59, s79
    s_setprio 2
    v_exp_f32 v27, v27
    v_exp_f32 v28, v28
    v_exp_f32 v29, v29
    v_exp_f32 v30, v30
    v_exp_f32 v31, v31
    v_exp_f32 v32, v32
    v_exp_f32 v33, v33
    v_smfmac_f32_32x32x32_bf16 v[48:63], v[88:91], v[24:31], v7
    v_exp_f32 v34, v34
    v_exp_f32 v35, v35
    v_exp_f32 v36, v36
    s_waitcnt vmcnt(7) lgkmcnt(0)
    v_mfma_f32_32x32x16_bf16 v[16:31], v[92:95], v[8:11], 0
    s_setprio 1
    ds_read_b64_tr_b16 a[34:35], v104 offset:2048
    ds_read_b64_tr_b16 a[38:39], v105 offset:2048
    ds_read_b64_tr_b16 a[42:43], v106 offset:2048
    ds_read_b64_tr_b16 a[46:47], v107 offset:2048
    v_exp_f32 v37, v37
    v_exp_f32 v38, v38
    v_exp_f32 v39, v39
    v_exp_f32 v40, v40
    v_exp_f32 v41, v41
    v_exp_f32 v42, v42
    s_add_u32 m0, s57, 0
    v_smfmac_f32_32x32x32_bf16 v[64:79], v[84:87], v[32:39], v7
    buffer_load_dwordx4 v5, s[16:19], s59 offen offset:0 lds
    s_setprio 0
    v_exp_f32 v43, v43
    v_exp_f32 v44, v44
    v_exp_f32 v45, v45
    v_exp_f32 v46, v46
    v_exp_f32 v47, v47
    v_exp_f32 v16, v16
    v_exp_f32 v17, v17
    v_smfmac_f32_32x32x32_bf16 v[64:79], v[88:91], v[40:47], v7
    s_setprio 3
    s_barrier
    ds_read_b128 v[80:83], v1 offset:16640
    ds_read_b128 v[84:87], v2 offset:16640
    ds_read_b128 v[88:91], v3 offset:16640
    v_exp_f32 v18, v18
    v_exp_f32 v19, v19
    v_exp_f32 v20, v20
    v_mfma_f32_32x32x16_bf16 v[32:47], v[92:95], v[12:15], 0
    v_exp_f32 v21, v21
    v_exp_f32 v22, v22
    v_exp_f32 v23, v23
    v_exp_f32 v24, v24
    v_exp_f32 v25, v25
    v_exp_f32 v26, v26
    s_add_u32 m0, s54, 8320
    v_smfmac_f32_32x32x32_bf16 v[48:63], v[96:99], v[16:23], v7
    buffer_load_dwordx4 v4, s[40:43], s53 offen sc1 lds
    s_add_u32 s53, s53, 4096
    v_exp_f32 v27, v27
    v_exp_f32 v28, v28
    v_exp_f32 v29, v29
    v_exp_f32 v30, v30
    v_exp_f32 v31, v31
    v_exp_f32 v32, v32
    v_exp_f32 v33, v33
    v_smfmac_f32_32x32x32_bf16 v[48:63], v[100:103], v[24:31], v7
    v_exp_f32 v34, v34
    v_exp_f32 v35, v35
    v_exp_f32 v36, v36
    s_waitcnt lgkmcnt(0)
    v_mfma_f32_32x32x16_bf16 v[16:31], v[80:83], v[8:11], 0
    v_exp_f32 v37, v37
    v_exp_f32 v38, v38
    v_exp_f32 v39, v39
    v_exp_f32 v40, v40
    v_exp_f32 v41, v41
    v_exp_f32 v42, v42
    s_add_u32 m0, s57, 0
    v_smfmac_f32_32x32x32_bf16 v[64:79], v[96:99], v[32:39], v7
    buffer_load_dwordx4 v6, s[16:19], s59 offen offset:1024 lds
    s_add_u32 s59, s59, s79
    v_exp_f32 v43, v43
    v_exp_f32 v44, v44
    v_exp_f32 v45, v45
    v_exp_f32 v46, v46
    v_exp_f32 v47, v47
    v_exp_f32 v16, v16
    v_exp_f32 v17, v17
    v_smfmac_f32_32x32x32_bf16 v[64:79], v[100:103], v[40:47], v7
    ds_read_b128 v[92:95], v1 offset:18720
    ds_read_b128 v[96:99], v2 offset:18720
    ds_read_b128 v[100:103], v3 offset:18720
    v_exp_f32 v18, v18
    v_exp_f32 v19, v19
    v_exp_f32 v20, v20
    v_mfma_f32_32x32x16_bf16 v[32:47], v[80:83], v[12:15], 0
    v_exp_f32 v21, v21
    v_exp_f32 v22, v22
    v_exp_f32 v23, v23
    v_exp_f32 v24, v24
    v_exp_f32 v25, v25
    v_exp_f32 v26, v26
    s_add_u32 m0, s57, 2048
    v_smfmac_f32_32x32x32_bf16 v[48:63], v[84:87], v[16:23], v7
    buffer_load_dwordx4 v5, s[16:19], s59 offen offset:0 lds
    s_setprio 2
    v_exp_f32 v27, v27
    v_exp_f32 v28, v28
    v_exp_f32 v29, v29
    v_exp_f32 v30, v30
    v_exp_f32 v31, v31
    v_exp_f32 v32, v32
    v_exp_f32 v33, v33
    v_smfmac_f32_32x32x32_bf16 v[48:63], v[88:91], v[24:31], v7
    v_exp_f32 v34, v34
    v_exp_f32 v35, v35
    v_exp_f32 v36, v36
    s_waitcnt vmcnt(6) lgkmcnt(0)
    v_mfma_f32_32x32x16_bf16 v[16:31], v[92:95], v[8:11], 0
    s_setprio 1
    ds_read_b64_tr_b16 a[48:49], v104 offset:32768
    ds_read_b64_tr_b16 a[52:53], v105 offset:32768
    ds_read_b64_tr_b16 a[56:57], v106 offset:32768
    ds_read_b64_tr_b16 a[60:61], v107 offset:32768
    v_exp_f32 v37, v37
    v_exp_f32 v38, v38
    v_exp_f32 v39, v39
    v_exp_f32 v40, v40
    v_exp_f32 v41, v41
    v_exp_f32 v42, v42
    v_smfmac_f32_32x32x32_bf16 v[64:79], v[84:87], v[32:39], v7
    buffer_load_dwordx4 v6, s[16:19], s59 offen offset:1024 lds
    s_add_u32 s59, s59, s79
    s_setprio 0
    v_exp_f32 v43, v43
    v_exp_f32 v44, v44
    v_exp_f32 v45, v45
    v_exp_f32 v46, v46
    v_exp_f32 v47, v47
    v_exp_f32 v16, v16
    v_exp_f32 v17, v17
    v_smfmac_f32_32x32x32_bf16 v[64:79], v[88:91], v[40:47], v7
    s_setprio 3
    s_barrier
    ds_read_b128 v[80:83], v1 offset:0
    ds_read_b128 v[84:87], v2 offset:0
    ds_read_b128 v[88:91], v3 offset:0
    v_exp_f32 v18, v18
    v_exp_f32 v19, v19
    v_exp_f32 v20, v20
    v_mfma_f32_32x32x16_bf16 v[32:47], v[92:95], v[12:15], 0
    v_exp_f32 v21, v21
    v_exp_f32 v22, v22
    v_exp_f32 v23, v23
    v_exp_f32 v24, v24
    v_exp_f32 v25, v25
    v_exp_f32 v26, v26
    s_add_u32 m0, s54, 16640
    v_smfmac_f32_32x32x32_bf16 v[48:63], v[96:99], v[16:23], v7
    buffer_load_dwordx4 v4, s[40:43], s53 offen sc1 lds
    s_add_u32 s53, s53, 4096
    v_exp_f32 v27, v27
    v_exp_f32 v28, v28
    v_exp_f32 v29, v29
    v_exp_f32 v30, v30
    v_exp_f32 v31, v31
    v_exp_f32 v32, v32
    v_exp_f32 v33, v33
    v_smfmac_f32_32x32x32_bf16 v[48:63], v[100:103], v[24:31], v7
    v_exp_f32 v34, v34
    v_exp_f32 v35, v35
    v_exp_f32 v36, v36
    s_waitcnt lgkmcnt(0)
    v_mfma_f32_32x32x16_bf16 v[16:31], v[80:83], v[8:11], 0
    v_exp_f32 v37, v37
    v_exp_f32 v38, v38
    v_exp_f32 v39, v39
    v_exp_f32 v40, v40
    v_exp_f32 v41, v41
    v_exp_f32 v42, v42
    s_add_u32 m0, s58, 16384
    s_mov_b32 s66, 0x50000
    v_smfmac_f32_32x32x32_bf16 v[64:79], v[96:99], v[32:39], v7
    buffer_load_dwordx4 v108, s[12:15], s66 offen lds
    v_exp_f32 v43, v43
    v_exp_f32 v44, v44
    v_exp_f32 v45, v45
    v_exp_f32 v46, v46
    v_exp_f32 v47, v47
    v_exp_f32 v16, v16
    v_exp_f32 v17, v17
    v_smfmac_f32_32x32x32_bf16 v[64:79], v[100:103], v[40:47], v7
    ds_read_b128 v[92:95], v1 offset:2080
    ds_read_b128 v[96:99], v2 offset:2080
    ds_read_b128 v[100:103], v3 offset:2080
    v_exp_f32 v18, v18
    v_exp_f32 v19, v19
    v_exp_f32 v20, v20
    v_mfma_f32_32x32x16_bf16 v[32:47], v[80:83], v[12:15], 0
    v_exp_f32 v21, v21
    v_exp_f32 v22, v22
    v_exp_f32 v23, v23
    v_exp_f32 v24, v24
    v_exp_f32 v25, v25
    v_exp_f32 v26, v26
    s_add_u32 m0, s57, 32768
    v_smfmac_f32_32x32x32_bf16 v[48:63], v[84:87], v[16:23], v7
    buffer_load_dwordx4 v5, s[16:19], s59 offen offset:0 lds
    s_setprio 2
    v_exp_f32 v27, v27
    v_exp_f32 v28, v28
    v_exp_f32 v29, v29
    v_exp_f32 v30, v30
    v_exp_f32 v31, v31
    v_exp_f32 v32, v32
    v_exp_f32 v33, v33
    v_smfmac_f32_32x32x32_bf16 v[48:63], v[88:91], v[24:31], v7
    v_exp_f32 v34, v34
    v_exp_f32 v35, v35
    v_exp_f32 v36, v36
    s_waitcnt vmcnt(6) lgkmcnt(0)
    v_mfma_f32_32x32x16_bf16 v[16:31], v[92:95], v[8:11], 0
    s_setprio 1
    ds_read_b64_tr_b16 a[50:51], v104 offset:34816
    ds_read_b64_tr_b16 a[54:55], v105 offset:34816
    ds_read_b64_tr_b16 a[58:59], v106 offset:34816
    ds_read_b64_tr_b16 a[62:63], v107 offset:34816
    v_exp_f32 v37, v37
    v_exp_f32 v38, v38
    v_exp_f32 v39, v39
    v_exp_f32 v40, v40
    v_exp_f32 v41, v41
    v_exp_f32 v42, v42
    v_smfmac_f32_32x32x32_bf16 v[64:79], v[84:87], v[32:39], v7
    buffer_load_dwordx4 v6, s[16:19], s59 offen offset:1024 lds
    s_add_u32 s59, s59, s79
    s_setprio 0
    v_exp_f32 v43, v43
    v_exp_f32 v44, v44
    v_exp_f32 v45, v45
    v_exp_f32 v46, v46
    v_exp_f32 v47, v47
    v_exp_f32 v16, v16
    v_exp_f32 v17, v17
    v_smfmac_f32_32x32x32_bf16 v[64:79], v[88:91], v[40:47], v7
    s_setprio 3
    s_barrier
    ds_read_b128 v[80:83], v1 offset:8320
    ds_read_b128 v[84:87], v2 offset:8320
    ds_read_b128 v[88:91], v3 offset:8320
    v_exp_f32 v18, v18
    v_exp_f32 v19, v19
    v_exp_f32 v20, v20
    v_mfma_f32_32x32x16_bf16 v[32:47], v[92:95], v[12:15], 0
    v_exp_f32 v21, v21
    v_exp_f32 v22, v22
    v_exp_f32 v23, v23
    v_exp_f32 v24, v24
    v_exp_f32 v25, v25
    v_exp_f32 v26, v26
    s_add_u32 m0, s54, 0
    v_smfmac_f32_32x32x32_bf16 v[48:63], v[96:99], v[16:23], v7
    buffer_load_dwordx4 v4, s[40:43], s53 offen sc1 lds
    s_add_u32 s53, s53, 4096
    v_exp_f32 v27, v27
    v_exp_f32 v28, v28
    v_exp_f32 v29, v29
    v_exp_f32 v30, v30
    v_exp_f32 v31, v31
    v_exp_f32 v32, v32
    v_exp_f32 v33, v33
    v_smfmac_f32_32x32x32_bf16 v[48:63], v[100:103], v[24:31], v7
    v_exp_f32 v34, v34
    v_exp_f32 v35, v35
    v_exp_f32 v36, v36
    s_waitcnt vmcnt(7) lgkmcnt(0)
    v_mfma_f32_32x32x16_bf16 v[16:31], v[80:83], v[8:11], 0
    ds_read_b64_tr_b16 a[64:65], v104 offset:0
    ds_read_b64_tr_b16 a[68:69], v105 offset:0
    ds_read_b64_tr_b16 a[72:73], v106 offset:0
    ds_read_b64_tr_b16 a[76:77], v107 offset:0
    v_exp_f32 v37, v37
    v_exp_f32 v38, v38
    v_exp_f32 v39, v39
    v_exp_f32 v40, v40
    v_exp_f32 v41, v41
    v_exp_f32 v42, v42
    s_add_u32 m0, s57, 34816
    v_smfmac_f32_32x32x32_bf16 v[64:79], v[96:99], v[32:39], v7
    buffer_load_dwordx4 v5, s[16:19], s59 offen offset:0 lds
    v_exp_f32 v43, v43
    v_exp_f32 v44, v44
    v_exp_f32 v45, v45
    v_exp_f32 v46, v46
    v_exp_f32 v47, v47
    v_exp_f32 v16, v16
    v_exp_f32 v17, v17
    v_smfmac_f32_32x32x32_bf16 v[64:79], v[100:103], v[40:47], v7
    ds_read_b128 v[92:95], v1 offset:10400
    ds_read_b128 v[96:99], v2 offset:10400
    ds_read_b128 v[100:103], v3 offset:10400
    v_exp_f32 v18, v18
    v_exp_f32 v19, v19
    v_exp_f32 v20, v20
    v_mfma_f32_32x32x16_bf16 v[32:47], v[80:83], v[12:15], 0
    v_exp_f32 v21, v21
    v_exp_f32 v22, v22
    v_exp_f32 v23, v23
    v_exp_f32 v24, v24
    v_exp_f32 v25, v25
    v_exp_f32 v26, v26
    v_smfmac_f32_32x32x32_bf16 v[48:63], v[84:87], v[16:23], v7
    buffer_load_dwordx4 v6, s[16:19], s59 offen offset:1024 lds
    s_add_u32 s59, s59, s79
    s_setprio 2
    v_exp_f32 v27, v27
    v_exp_f32 v28, v28
    v_exp_f32 v29, v29
    v_exp_f32 v30, v30
    v_exp_f32 v31, v31
    v_exp_f32 v32, v32
    v_exp_f32 v33, v33
    v_smfmac_f32_32x32x32_bf16 v[48:63], v[88:91], v[24:31], v7
    v_exp_f32 v34, v34
    v_exp_f32 v35, v35
    v_exp_f32 v36, v36
    s_waitcnt vmcnt(6) lgkmcnt(0)
    v_mfma_f32_32x32x16_bf16 v[16:31], v[92:95], v[8:11], 0
    s_setprio 1
    v_exp_f32 v37, v37
    v_exp_f32 v38, v38
    v_exp_f32 v39, v39
    v_exp_f32 v40, v40
    v_exp_f32 v41, v41
    v_exp_f32 v42, v42
    s_add_u32 m0, s57, 0
    v_smfmac_f32_32x32x32_bf16 v[64:79], v[84:87], v[32:39], v7
    buffer_load_dwordx4 v5, s[16:19], s59 offen offset:0 lds
    s_setprio 0
    v_exp_f32 v43, v43
    v_exp_f32 v44, v44
    v_exp_f32 v45, v45
    v_exp_f32 v46, v46
    v_exp_f32 v47, v47
    v_exp_f32 v16, v16
    v_exp_f32 v17, v17
    v_smfmac_f32_32x32x32_bf16 v[64:79], v[88:91], v[40:47], v7
    s_setprio 3
    s_barrier
    ds_read_b128 v[80:83], v1 offset:16640
    ds_read_b128 v[84:87], v2 offset:16640
    ds_read_b128 v[88:91], v3 offset:16640
    v_exp_f32 v18, v18
    v_exp_f32 v19, v19
    v_exp_f32 v20, v20
    v_mfma_f32_32x32x16_bf16 v[32:47], v[92:95], v[12:15], 0
    v_exp_f32 v21, v21
    buffer_load_dword v124, v4, s[36:39], 0 offen sc1
    v_exp_f32 v22, v22
    v_exp_f32 v23, v23
    v_exp_f32 v24, v24
    v_exp_f32 v25, v25
    v_exp_f32 v26, v26
    s_add_u32 m0, s54, 8320
    v_smfmac_f32_32x32x32_bf16 v[48:63], v[96:99], v[16:23], v7
    buffer_load_dwordx4 v4, s[40:43], s53 offen sc1 lds
    s_add_u32 s53, s53, 4096
    v_exp_f32 v27, v27
    v_exp_f32 v28, v28
    v_exp_f32 v29, v29
    v_exp_f32 v30, v30
    v_exp_f32 v31, v31
    v_exp_f32 v32, v32
    v_exp_f32 v33, v33
    v_smfmac_f32_32x32x32_bf16 v[48:63], v[100:103], v[24:31], v7
    v_exp_f32 v34, v34
    v_exp_f32 v35, v35
    v_exp_f32 v36, v36
    s_waitcnt lgkmcnt(0)
    v_mfma_f32_32x32x16_bf16 v[16:31], v[80:83], v[8:11], 0
    ds_read_b64_tr_b16 a[66:67], v104 offset:2048
    ds_read_b64_tr_b16 a[70:71], v105 offset:2048
    ds_read_b64_tr_b16 a[74:75], v106 offset:2048
    ds_read_b64_tr_b16 a[78:79], v107 offset:2048
    v_exp_f32 v37, v37
    v_exp_f32 v38, v38
    v_exp_f32 v39, v39
    v_exp_f32 v40, v40
    v_exp_f32 v41, v41
    v_exp_f32 v42, v42
    s_add_u32 m0, s58, 24576
    s_mov_b32 s66, 0x20000
    v_smfmac_f32_32x32x32_bf16 v[64:79], v[96:99], v[32:39], v7
    buffer_load_dwordx4 v108, s[12:15], s66 offen lds
    v_exp_f32 v43, v43
    v_exp_f32 v44, v44
    v_exp_f32 v45, v45
    v_exp_f32 v46, v46
    v_exp_f32 v47, v47
    v_exp_f32 v16, v16
    v_exp_f32 v17, v17
    v_smfmac_f32_32x32x32_bf16 v[64:79], v[100:103], v[40:47], v7
    ds_read_b128 v[92:95], v1 offset:18720
    ds_read_b128 v[96:99], v2 offset:18720
    ds_read_b128 v[100:103], v3 offset:18720
    v_exp_f32 v18, v18
    v_exp_f32 v19, v19
    v_exp_f32 v20, v20
    v_mfma_f32_32x32x16_bf16 v[32:47], v[80:83], v[12:15], 0
    v_exp_f32 v21, v21
    v_exp_f32 v22, v22
    v_exp_f32 v23, v23
    v_exp_f32 v24, v24
    v_exp_f32 v25, v25
    v_exp_f32 v26, v26
    s_add_u32 m0, s57, 0
    v_smfmac_f32_32x32x32_bf16 v[48:63], v[84:87], v[16:23], v7
    buffer_load_dwordx4 v6, s[16:19], s59 offen offset:1024 lds
    s_add_u32 s59, s59, s79
    s_setprio 2
    v_exp_f32 v27, v27
    v_exp_f32 v28, v28
    v_exp_f32 v29, v29
    v_exp_f32 v30, v30
    v_exp_f32 v31, v31
    v_exp_f32 v32, v32
    v_exp_f32 v33, v33
    v_smfmac_f32_32x32x32_bf16 v[48:63], v[88:91], v[24:31], v7
    v_exp_f32 v34, v34
    v_exp_f32 v35, v35
    v_exp_f32 v36, v36
    s_waitcnt vmcnt(7) lgkmcnt(0)
    v_mfma_f32_32x32x16_bf16 v[16:31], v[92:95], v[8:11], 0
    s_setprio 1
    ds_read_b64_tr_b16 a[80:81], v104 offset:32768
    ds_read_b64_tr_b16 a[84:85], v105 offset:32768
    ds_read_b64_tr_b16 a[88:89], v106 offset:32768
    ds_read_b64_tr_b16 a[92:93], v107 offset:32768
    v_exp_f32 v37, v37
    buffer_load_dword v110, off, s[20:23], s87
    v_exp_f32 v38, v38
    v_exp_f32 v39, v39
    v_exp_f32 v40, v40
    v_exp_f32 v41, v41
    v_exp_f32 v42, v42
    s_add_u32 m0, s57, 2048
    v_smfmac_f32_32x32x32_bf16 v[64:79], v[84:87], v[32:39], v7
    buffer_load_dwordx4 v5, s[16:19], s59 offen offset:0 lds
    s_setprio 0
    v_exp_f32 v43, v43
    v_exp_f32 v44, v44
    v_exp_f32 v45, v45
    v_exp_f32 v46, v46
    v_exp_f32 v47, v47
    v_exp_f32 v16, v16
    v_exp_f32 v17, v17
    v_smfmac_f32_32x32x32_bf16 v[64:79], v[88:91], v[40:47], v7
    s_setprio 3
    s_barrier
    ds_read_b128 v[80:83], v1 offset:0
    ds_read_b128 v[84:87], v2 offset:0
    ds_read_b128 v[88:91], v3 offset:0
    v_exp_f32 v18, v18
    v_exp_f32 v19, v19
    v_exp_f32 v20, v20
    v_mfma_f32_32x32x16_bf16 v[32:47], v[92:95], v[12:15], 0
    v_exp_f32 v21, v21
    v_exp_f32 v22, v22
    v_exp_f32 v23, v23
    v_exp_f32 v24, v24
    v_exp_f32 v25, v25
    v_exp_f32 v26, v26
    s_add_u32 m0, s54, 16640
    v_smfmac_f32_32x32x32_bf16 v[48:63], v[96:99], v[16:23], v7
    buffer_load_dwordx4 v4, s[40:43], s53 offen sc1 lds
    s_add_u32 s53, s53, 4096
    v_exp_f32 v27, v27
    v_exp_f32 v28, v28
    v_exp_f32 v29, v29
    v_exp_f32 v30, v30
    v_exp_f32 v31, v31
    v_exp_f32 v32, v32
    v_exp_f32 v33, v33
    v_smfmac_f32_32x32x32_bf16 v[48:63], v[100:103], v[24:31], v7
    v_exp_f32 v34, v34
    v_exp_f32 v35, v35
    v_exp_f32 v36, v36
    s_waitcnt lgkmcnt(0)
    v_mfma_f32_32x32x16_bf16 v[16:31], v[80:83], v[8:11], 0
    v_exp_f32 v37, v37
    buffer_load_dword v110, off, s[28:31], s88
    v_exp_f32 v38, v38
    v_exp_f32 v39, v39
    v_exp_f32 v40, v40
    v_exp_f32 v41, v41
    v_exp_f32 v42, v42
    s_add_u32 m0, s57, 2048
    v_smfmac_f32_32x32x32_bf16 v[64:79], v[96:99], v[32:39], v7
    buffer_load_dwordx4 v6, s[16:19], s59 offen offset:1024 lds
    s_add_u32 s59, s59, s79
    v_exp_f32 v43, v43
    v_exp_f32 v44, v44
    v_exp_f32 v45, v45
    v_exp_f32 v46, v46
    v_exp_f32 v47, v47
    v_exp_f32 v16, v16
    v_exp_f32 v17, v17
    v_smfmac_f32_32x32x32_bf16 v[64:79], v[100:103], v[40:47], v7
    ds_read_b128 v[92:95], v1 offset:2080
    ds_read_b128 v[96:99], v2 offset:2080
    ds_read_b128 v[100:103], v3 offset:2080
    v_exp_f32 v18, v18
    v_exp_f32 v19, v19
    v_exp_f32 v20, v20
    v_mfma_f32_32x32x16_bf16 v[32:47], v[80:83], v[12:15], 0
    v_exp_f32 v21, v21
    v_exp_f32 v22, v22
    v_exp_f32 v23, v23
    v_exp_f32 v24, v24
    v_exp_f32 v25, v25
    v_exp_f32 v26, v26
    s_add_u32 m0, s57, 32768
    v_smfmac_f32_32x32x32_bf16 v[48:63], v[84:87], v[16:23], v7
    buffer_load_dwordx4 v5, s[16:19], s59 offen offset:0 lds
    s_setprio 2
    v_exp_f32 v27, v27
    v_exp_f32 v28, v28
    v_exp_f32 v29, v29
    v_exp_f32 v30, v30
    v_exp_f32 v31, v31
    v_exp_f32 v32, v32
    v_exp_f32 v33, v33
    v_smfmac_f32_32x32x32_bf16 v[48:63], v[88:91], v[24:31], v7
    v_exp_f32 v34, v34
    v_exp_f32 v35, v35
    v_exp_f32 v36, v36
    s_waitcnt vmcnt(8) lgkmcnt(0)
    v_mfma_f32_32x32x16_bf16 v[16:31], v[92:95], v[8:11], 0
    s_setprio 1
    ds_read_b64_tr_b16 a[82:83], v104 offset:34816
    ds_read_b64_tr_b16 a[86:87], v105 offset:34816
    ds_read_b64_tr_b16 a[90:91], v106 offset:34816
    ds_read_b64_tr_b16 a[94:95], v107 offset:34816
    v_exp_f32 v37, v37
    v_exp_f32 v38, v38
    v_exp_f32 v39, v39
    v_exp_f32 v40, v40
    v_exp_f32 v41, v41
    v_exp_f32 v42, v42
    v_smfmac_f32_32x32x32_bf16 v[64:79], v[84:87], v[32:39], v7
    buffer_load_dwordx4 v6, s[16:19], s59 offen offset:1024 lds
    s_add_u32 s59, s59, s79
    s_setprio 0
    v_exp_f32 v43, v43
    v_exp_f32 v44, v44
    v_exp_f32 v45, v45
    v_exp_f32 v46, v46
    v_exp_f32 v47, v47
    v_exp_f32 v16, v16
    v_exp_f32 v17, v17
    v_smfmac_f32_32x32x32_bf16 v[64:79], v[88:91], v[40:47], v7
    s_setprio 3
    s_barrier
    ds_read_b128 v[80:83], v1 offset:8320
    ds_read_b128 v[84:87], v2 offset:8320
    ds_read_b128 v[88:91], v3 offset:8320
    v_exp_f32 v18, v18
    v_exp_f32 v19, v19
    v_exp_f32 v20, v20
    v_mfma_f32_32x32x16_bf16 v[32:47], v[92:95], v[12:15], 0
    v_exp_f32 v21, v21
    v_exp_f32 v22, v22
    v_exp_f32 v23, v23
    v_exp_f32 v24, v24
    v_exp_f32 v25, v25
    v_exp_f32 v26, v26
    s_add_u32 m0, s54, 0
    v_smfmac_f32_32x32x32_bf16 v[48:63], v[96:99], v[16:23], v7
    buffer_load_dwordx4 v4, s[40:43], s53 offen sc1 lds
    s_add_u32 s53, s53, 4096
    v_exp_f32 v27, v27
    v_exp_f32 v28, v28
    v_exp_f32 v29, v29
    v_exp_f32 v30, v30
    v_exp_f32 v31, v31
    v_exp_f32 v32, v32
    v_exp_f32 v33, v33
    v_smfmac_f32_32x32x32_bf16 v[48:63], v[100:103], v[24:31], v7
    v_exp_f32 v34, v34
    v_exp_f32 v35, v35
    v_exp_f32 v36, v36
    s_waitcnt vmcnt(8) lgkmcnt(0)
    v_mfma_f32_32x32x16_bf16 v[16:31], v[80:83], v[8:11], 0
    ds_read_b64_tr_b16 a[96:97], v104 offset:0
    ds_read_b64_tr_b16 a[100:101], v105 offset:0
    ds_read_b64_tr_b16 a[104:105], v106 offset:0
    ds_read_b64_tr_b16 a[108:109], v107 offset:0
    v_exp_f32 v37, v37
    v_exp_f32 v38, v38
    v_exp_f32 v39, v39
    v_exp_f32 v40, v40
    v_exp_f32 v41, v41
    v_exp_f32 v42, v42
    s_add_u32 m0, s57, 34816
    v_smfmac_f32_32x32x32_bf16 v[64:79], v[96:99], v[32:39], v7
    buffer_load_dwordx4 v5, s[16:19], s59 offen offset:0 lds
    v_exp_f32 v43, v43
    v_exp_f32 v44, v44
    v_exp_f32 v45, v45
    v_exp_f32 v46, v46
    v_exp_f32 v47, v47
    v_exp_f32 v16, v16
    v_exp_f32 v17, v17
    v_smfmac_f32_32x32x32_bf16 v[64:79], v[100:103], v[40:47], v7
    ds_read_b128 v[92:95], v1 offset:10400
    ds_read_b128 v[96:99], v2 offset:10400
    ds_read_b128 v[100:103], v3 offset:10400
    v_exp_f32 v18, v18
    v_exp_f32 v19, v19
    v_exp_f32 v20, v20
    v_mfma_f32_32x32x16_bf16 v[32:47], v[80:83], v[12:15], 0
    s_add_u32 m0, s58, 32768
    s_mov_b32 s66, 0x0
    v_exp_f32 v21, v21
    buffer_load_dwordx4 v108, s[12:15], s66 offen lds
    v_exp_f32 v22, v22
    v_exp_f32 v23, v23
    v_exp_f32 v24, v24
    v_exp_f32 v25, v25
    v_exp_f32 v26, v26
    s_add_u32 m0, s57, 34816
    v_smfmac_f32_32x32x32_bf16 v[48:63], v[84:87], v[16:23], v7
    buffer_load_dwordx4 v6, s[16:19], s59 offen offset:1024 lds
    s_setprio 2
    v_exp_f32 v27, v27
    v_exp_f32 v28, v28
    v_exp_f32 v29, v29
    v_exp_f32 v30, v30
    v_exp_f32 v31, v31
    v_exp_f32 v32, v32
    v_exp_f32 v33, v33
    v_smfmac_f32_32x32x32_bf16 v[48:63], v[88:91], v[24:31], v7
    v_exp_f32 v34, v34
    v_exp_f32 v35, v35
    v_exp_f32 v36, v36
    s_waitcnt vmcnt(6) lgkmcnt(0)
    v_mfma_f32_32x32x16_bf16 v[16:31], v[92:95], v[8:11], 0
    s_setprio 1
    ds_read_b64_tr_b16 a[98:99], v104 offset:2048
    ds_read_b64_tr_b16 a[102:103], v105 offset:2048
    ds_read_b64_tr_b16 a[106:107], v106 offset:2048
    ds_read_b64_tr_b16 a[110:111], v107 offset:2048
    v_exp_f32 v37, v37
    v_exp_f32 v38, v38
    v_exp_f32 v39, v39
    v_exp_f32 v40, v40
    v_exp_f32 v41, v41
    v_exp_f32 v42, v42
    s_add_u32 m0, s57, 0
    s_add_u32 s67, s85, 0
    v_smfmac_f32_32x32x32_bf16 v[64:79], v[84:87], v[32:39], v7
    buffer_load_dwordx4 v125, s[24:27], s67 offen offset:0 lds
    s_setprio 0
    v_exp_f32 v43, v43
    v_exp_f32 v44, v44
    v_exp_f32 v45, v45
    v_exp_f32 v46, v46
    v_exp_f32 v47, v47
    v_exp_f32 v16, v16
    v_exp_f32 v17, v17
    v_smfmac_f32_32x32x32_bf16 v[64:79], v[88:91], v[40:47], v7
    s_setprio 3
    s_barrier
    ds_read_b128 v[80:83], v1 offset:16640
    ds_read_b128 v[84:87], v2 offset:16640
    ds_read_b128 v[88:91], v3 offset:16640
    v_exp_f32 v18, v18
    v_exp_f32 v19, v19
    v_exp_f32 v20, v20
    v_mfma_f32_32x32x16_bf16 v[32:47], v[92:95], v[12:15], 0
    s_add_u32 m0, s58, 40960
    s_mov_b32 s66, 0x30000
    v_exp_f32 v21, v21
    buffer_load_dwordx4 v108, s[12:15], s66 offen lds
    v_exp_f32 v22, v22
    v_exp_f32 v23, v23
    v_exp_f32 v24, v24
    v_exp_f32 v25, v25
    v_exp_f32 v26, v26
    s_add_u32 m0, s57, 0
    v_smfmac_f32_32x32x32_bf16 v[48:63], v[96:99], v[16:23], v7
    buffer_load_dwordx4 v126, s[24:27], s67 offen offset:1024 lds
    v_exp_f32 v27, v27
    v_exp_f32 v28, v28
    v_exp_f32 v29, v29
    v_exp_f32 v30, v30
    v_exp_f32 v31, v31
    v_exp_f32 v32, v32
    v_exp_f32 v33, v33
    v_smfmac_f32_32x32x32_bf16 v[48:63], v[100:103], v[24:31], v7
    v_exp_f32 v34, v34
    v_exp_f32 v35, v35
    v_exp_f32 v36, v36
    s_waitcnt vmcnt(7) lgkmcnt(0)
    v_mfma_f32_32x32x16_bf16 v[16:31], v[80:83], v[8:11], 0
    ds_read_b64_tr_b16 a[112:113], v104 offset:32768
    ds_read_b64_tr_b16 a[116:117], v105 offset:32768
    ds_read_b64_tr_b16 a[120:121], v106 offset:32768
    ds_read_b64_tr_b16 a[124:125], v107 offset:32768
    v_exp_f32 v37, v37
    v_exp_f32 v38, v38
    v_exp_f32 v39, v39
    v_exp_f32 v40, v40
    v_exp_f32 v41, v41
    v_exp_f32 v42, v42
    v_smfmac_f32_32x32x32_bf16 v[64:79], v[96:99], v[32:39], v7
    s_cmp_lt_u32 s3, 4
    s_cbranch_scc1 P2_cw
    buffer_load_dwordx4 v[112:115], v111, s[4:7], s78 offen
    buffer_load_dwordx4 v[116:119], v111, s[4:7], s78 offen offset:16
P2_cw_e:
    v_exp_f32 v43, v43
    v_exp_f32 v44, v44
    v_exp_f32 v45, v45
    v_exp_f32 v46, v46
    v_exp_f32 v47, v47
    v_exp_f32 v16, v16
    v_exp_f32 v17, v17
    v_smfmac_f32_32x32x32_bf16 v[64:79], v[100:103], v[40:47], v7
    ds_read_b128 v[92:95], v1 offset:18720
    ds_read_b128 v[96:99], v2 offset:18720
    ds_read_b128 v[100:103], v3 offset:18720
    v_exp_f32 v18, v18
    v_exp_f32 v19, v19
    v_exp_f32 v20, v20
    v_mfma_f32_32x32x16_bf16 v[32:47], v[80:83], v[12:15], 0
    s_add_u32 m0, s58, 49152
    s_mov_b32 s66, 0x40000
    v_exp_f32 v21, v21
    buffer_load_dwordx4 v108, s[12:15], s66 offen lds
    v_exp_f32 v22, v22
    v_exp_f32 v23, v23
    v_exp_f32 v24, v24
    v_exp_f32 v25, v25
    v_exp_f32 v26, v26
    s_add_u32 m0, s57, 2048
    s_add_u32 s67, s85, 65536
    v_smfmac_f32_32x32x32_bf16 v[48:63], v[84:87], v[16:23], v7
    buffer_load_dwordx4 v125, s[24:27], s67 offen offset:0 lds
    s_setprio 2
    v_exp_f32 v27, v27
    v_exp_f32 v28, v28
    v_exp_f32 v29, v29
    v_exp_f32 v30, v30
    v_exp_f32 v31, v31
    v_exp_f32 v32, v32
    v_exp_f32 v33, v33
    v_smfmac_f32_32x32x32_bf16 v[48:63], v[88:91], v[24:31], v7
    v_exp_f32 v34, v34
    v_exp_f32 v35, v35
    v_exp_f32 v36, v36
    s_waitcnt vmcnt(7) lgkmcnt(0)
    v_mfma_f32_32x32x16_bf16 v[16:31], v[92:95], v[8:11], 0
    s_setprio 1
    ds_read_b64_tr_b16 a[114:115], v104 offset:34816
    ds_read_b64_tr_b16 a[118:119], v105 offset:34816
    ds_read_b64_tr_b16 a[122:123], v106 offset:34816
    ds_read_b64_tr_b16 a[126:127], v107 offset:34816
    v_exp_f32 v37, v37
    v_exp_f32 v38, v38
    v_exp_f32 v39, v39
    v_exp_f32 v40, v40
    v_exp_f32 v41, v41
    v_exp_f32 v42, v42
    v_smfmac_f32_32x32x32_bf16 v[64:79], v[84:87], v[32:39], v7
    buffer_load_dwordx4 v126, s[24:27], s67 offen offset:1024 lds
    s_setprio 0
    v_exp_f32 v43, v43
    v_exp_f32 v44, v44
    v_exp_f32 v45, v45
    v_exp_f32 v46, v46
    v_exp_f32 v47, v47
    v_exp_f32 v16, v16
    v_exp_f32 v17, v17
    v_smfmac_f32_32x32x32_bf16 v[64:79], v[88:91], v[40:47], v7
    s_setprio 3
    s_barrier
    ds_read_b128 v[80:83], v1 offset:0
    ds_read_b128 v[84:87], v2 offset:0
    ds_read_b128 v[88:91], v3 offset:0
    v_exp_f32 v18, v18
    v_exp_f32 v19, v19
    v_exp_f32 v20, v20
    v_mfma_f32_32x32x16_bf16 v[32:47], v[92:95], v[12:15], 0
    s_add_u32 m0, s58, 57344
    s_mov_b32 s66, 0x60000
    v_exp_f32 v21, v21
    buffer_load_dwordx4 v108, s[12:15], s66 offen lds
    v_exp_f32 v22, v22
    v_exp_f32 v23, v23
    v_exp_f32 v24, v24
    v_exp_f32 v25, v25
    v_exp_f32 v26, v26
    s_add_u32 m0, s57, 32768
    s_add_u32 s67, s85, 131072
    v_smfmac_f32_32x32x32_bf16 v[48:63], v[96:99], v[16:23], v7
    buffer_load_dwordx4 v125, s[24:27], s67 offen offset:0 lds
    v_exp_f32 v27, v27
    v_exp_f32 v28, v28
    v_exp_f32 v29, v29
    v_exp_f32 v30, v30
    v_exp_f32 v31, v31
    v_exp_f32 v32, v32
    v_exp_f32 v33, v33
    v_smfmac_f32_32x32x32_bf16 v[48:63], v[100:103], v[24:31], v7
    v_exp_f32 v34, v34
    v_exp_f32 v35, v35
    v_exp_f32 v36, v36
    s_waitcnt lgkmcnt(0)
    v_mfma_f32_32x32x16_bf16 v[16:31], v[80:83], v[8:11], 0
    v_exp_f32 v37, v37
    buffer_load_dword v110, v127, s[40:43], s63 offen sc1
    v_exp_f32 v38, v38
    v_exp_f32 v39, v39
    v_exp_f32 v40, v40
    v_exp_f32 v41, v41
    v_exp_f32 v42, v42
    v_smfmac_f32_32x32x32_bf16 v[64:79], v[96:99], v[32:39], v7
    buffer_load_dwordx4 v126, s[24:27], s67 offen offset:1024 lds
    v_exp_f32 v43, v43
    v_exp_f32 v44, v44
    v_exp_f32 v45, v45
    v_exp_f32 v46, v46
    v_exp_f32 v47, v47
    v_exp_f32 v16, v16
    v_exp_f32 v17, v17
    v_smfmac_f32_32x32x32_bf16 v[64:79], v[100:103], v[40:47], v7
    ds_read_b128 v[92:95], v1 offset:2080
    ds_read_b128 v[96:99], v2 offset:2080
    ds_read_b128 v[100:103], v3 offset:2080
    v_exp_f32 v18, v18
    v_exp_f32 v19, v19
    v_exp_f32 v20, v20
    v_mfma_f32_32x32x16_bf16 v[32:47], v[80:83], v[12:15], 0
    v_exp_f32 v21, v21
    v_exp_f32 v22, v22
    v_exp_f32 v23, v23
    v_exp_f32 v24, v24
    v_exp_f32 v25, v25
    v_exp_f32 v26, v26
    s_add_u32 m0, s57, 34816
    s_add_u32 s67, s85, 196608
    v_smfmac_f32_32x32x32_bf16 v[48:63], v[84:87], v[16:23], v7
    buffer_load_dwordx4 v125, s[24:27], s67 offen offset:0 lds
    v_exp_f32 v27, v27
    v_exp_f32 v28, v28
    v_exp_f32 v29, v29
    v_exp_f32 v30, v30
    v_exp_f32 v31, v31
    v_exp_f32 v32, v32
    v_exp_f32 v33, v33
    v_smfmac_f32_32x32x32_bf16 v[48:63], v[88:91], v[24:31], v7
    v_exp_f32 v34, v34
    v_exp_f32 v35, v35
    v_exp_f32 v36, v36
    s_waitcnt lgkmcnt(0)
    v_mfma_f32_32x32x16_bf16 v[16:31], v[92:95], v[8:11], 0
    v_exp_f32 v37, v37
    v_exp_f32 v38, v38
    v_exp_f32 v39, v39
    v_exp_f32 v40, v40
    v_exp_f32 v41, v41
    v_exp_f32 v42, v42
    v_smfmac_f32_32x32x32_bf16 v[64:79], v[84:87], v[32:39], v7
    buffer_load_dwordx4 v126, s[24:27], s67 offen offset:1024 lds
    v_exp_f32 v43, v43
    v_exp_f32 v44, v44
    v_exp_f32 v45, v45
    v_exp_f32 v46, v46
    v_exp_f32 v47, v47
    v_exp_f32 v16, v16
    v_exp_f32 v17, v17
    v_smfmac_f32_32x32x32_bf16 v[64:79], v[88:91], v[40:47], v7
    v_exp_f32 v18, v18
    v_exp_f32 v19, v19
    v_exp_f32 v20, v20
    v_mfma_f32_32x32x16_bf16 v[32:47], v[92:95], v[12:15], 0
    v_exp_f32 v21, v21
    v_exp_f32 v22, v22
    v_exp_f32 v23, v23
    v_exp_f32 v24, v24
    v_exp_f32 v25, v25
    v_exp_f32 v26, v26
    v_smfmac_f32_32x32x32_bf16 v[48:63], v[96:99], v[16:23], v7
    s_setprio 2
    v_exp_f32 v27, v27
    v_exp_f32 v28, v28
    v_exp_f32 v29, v29
    v_exp_f32 v30, v30
    v_exp_f32 v31, v31
    v_exp_f32 v32, v32
    v_exp_f32 v33, v33
    v_smfmac_f32_32x32x32_bf16 v[48:63], v[100:103], v[24:31], v7
    v_exp_f32 v34, v34
    v_exp_f32 v35, v35
    v_exp_f32 v36, v36
    s_setprio 1
    v_exp_f32 v37, v37
    v_exp_f32 v38, v38
    v_exp_f32 v39, v39
    v_exp_f32 v40, v40
    v_exp_f32 v41, v41
    v_exp_f32 v42, v42
    v_smfmac_f32_32x32x32_bf16 v[64:79], v[96:99], v[32:39], v7
    s_setprio 0
    v_exp_f32 v43, v43
    v_exp_f32 v44, v44
    ds_write_b128 v120, v[48:51]
    ds_write_b128 v120, v[52:55] offset:1024
    ds_write_b32 v122, v56 offset:2048
    v_exp_f32 v45, v45
    v_exp_f32 v46, v46
    v_exp_f32 v47, v47
    s_waitcnt vmcnt(5) lgkmcnt(0)
    s_cmp_ge_u32 s3, 4
    v_smfmac_f32_32x32x32_bf16 v[64:79], v[100:103], v[40:47], v7
    s_cbranch_scc1 P2_cmb
P2_g:
    v_cmp_ne_u32 s[66:67], 1, v124
    v_cmp_ne_u32 vcc, 1, v112
    s_and_b32 s66, s66, 0xff
    s_cbranch_scc1 P2_g_r
    s_cbranch_vccnz P2_g_r
P2_g_ok:
P2_cmb:
    s_barrier
    ds_read_b32 v28, v123 offset:2048
    ds_read_b128 v[20:23], v121
    ds_read_b128 v[24:27], v121 offset:1024
    s_mov_b32 s66, 0x1f800000
    s_mov_b32 s67, 0x5f800000
    s_nop 3
    s_waitcnt lgkmcnt(2)
    v_add_f32 v72, v72, v28
    v_cmp_nle_f32 vcc, s66, v72
    v_cmp_nge_f32 s[68:69], s67, v72
    v_rcp_f32 v28, v72
    s_waitcnt lgkmcnt(0)
    v_pk_add_f32 v[64:65], v[64:65], v[20:21]
    v_pk_add_f32 v[66:67], v[66:67], v[22:23]
    v_pk_add_f32 v[68:69], v[68:69], v[24:25]
    v_pk_add_f32 v[70:71], v[70:71], v[26:27]
    s_or_b64 vcc, vcc, s[68:69]
    s_cbranch_vccnz P2_slow
P2_fin:
    v_pk_mul_f32 v[64:65], v[64:65], v[28:29] op_sel_hi:[1,0]
    v_pk_mul_f32 v[66:67], v[66:67], v[28:29] op_sel_hi:[1,0]
    v_pk_mul_f32 v[68:69], v[68:69], v[28:29] op_sel_hi:[1,0]
    v_pk_mul_f32 v[70:71], v[70:71], v[28:29] op_sel_hi:[1,0]
    v_cvt_pk_bf16_f32 v20, v64, v65
    v_cvt_pk_bf16_f32 v21, v66, v67
    v_cvt_pk_bf16_f32 v22, v68, v69
    v_cvt_pk_bf16_f32 v23, v70, v71
    buffer_store_dwordx4 v[20:23], v4, s[40:43], s60 offen sc1
    s_cmp_lt_u32 s3, 4
    s_cbranch_scc1 P3_relay
    v_bfe_u32 v6, v0, 2, 2
    v_lshrrev_b32 v11, 5, v0
    v_lshl_add_u32 v7, v11, 2, v6
    v_lshlrev_b32 v7, 7, v7
    v_and_b32 v8, 1, v0
    v_lshlrev_b32 v8, 2, v8
    v_bfe_u32 v9, v0, 4, 1
    v_lshl_add_u32 v8, v9, 1, v8
    v_bfe_u32 v9, v0, 1, 1
    s_and_b32 s66, s3, 2
    s_lshl_b32 s66, s66, 2
    v_add3_u32 v8, v8, v9, s66
    v_lshrrev_b32 v9, 1, v6
    v_lshlrev_b32 v9, 3, v9
    v_xor_b32 v8, v8, v9
    v_lshl_add_u32 v5, v8, 3, v7
    ds_read_b64_tr_b16 v[32:33], v5 offset:0
    ds_read_b64_tr_b16 v[34:35], v5 offset:1024
    ds_read_b64_tr_b16 v[36:37], v5 offset:2048
    ds_read_b64_tr_b16 v[38:39], v5 offset:3072
    ds_read_b64_tr_b16 v[40:41], v5 offset:4096
    ds_read_b64_tr_b16 v[42:43], v5 offset:5120
    ds_read_b64_tr_b16 v[44:45], v5 offset:6144
    ds_read_b64_tr_b16 v[46:47], v5 offset:7168
    ds_read_b64_tr_b16 v[48:49], v5 offset:8192
    ds_read_b64_tr_b16 v[50:51], v5 offset:9216
    ds_read_b64_tr_b16 v[52:53], v5 offset:10240
    ds_read_b64_tr_b16 v[54:55], v5 offset:11264
    ds_read_b64_tr_b16 v[56:57], v5 offset:12288
    ds_read_b64_tr_b16 v[58:59], v5 offset:13312
    ds_read_b64_tr_b16 v[60:61], v5 offset:14336
    ds_read_b64_tr_b16 v[62:63], v5 offset:15360
    ds_read_b64_tr_b16 v[64:65], v5 offset:16384
    ds_read_b64_tr_b16 v[66:67], v5 offset:17408
    v_lshlrev_b32 v16, 16, v112
    v_and_b32 v17, 0xffff0000, v112
    ds_read_b64_tr_b16 v[68:69], v5 offset:18432
    ds_read_b64_tr_b16 v[70:71], v5 offset:19456
    v_lshlrev_b32 v18, 16, v113
    v_and_b32 v19, 0xffff0000, v113
    ds_read_b64_tr_b16 v[72:73], v5 offset:20480
    ds_read_b64_tr_b16 v[74:75], v5 offset:21504
    v_lshlrev_b32 v20, 16, v114
    v_and_b32 v21, 0xffff0000, v114
    ds_read_b64_tr_b16 v[76:77], v5 offset:22528
    ds_read_b64_tr_b16 v[78:79], v5 offset:23552
    v_lshlrev_b32 v22, 16, v115
    v_and_b32 v23, 0xffff0000, v115
    ds_read_b64_tr_b16 v[80:81], v5 offset:24576
    ds_read_b64_tr_b16 v[82:83], v5 offset:25600
    v_lshlrev_b32 v24, 16, v116
    v_and_b32 v25, 0xffff0000, v116
    ds_read_b64_tr_b16 v[84:85], v5 offset:26624
    ds_read_b64_tr_b16 v[86:87], v5 offset:27648
    v_lshlrev_b32 v26, 16, v117
    v_and_b32 v27, 0xffff0000, v117
    ds_read_b64_tr_b16 v[88:89], v5 offset:28672
    ds_read_b64_tr_b16 v[90:91], v5 offset:29696
    v_lshlrev_b32 v28, 16, v118
    v_and_b32 v29, 0xffff0000, v118
    ds_read_b64_tr_b16 v[92:93], v5 offset:30720
    ds_read_b64_tr_b16 v[94:95], v5 offset:31744
    v_lshlrev_b32 v30, 16, v119
    v_and_b32 v31, 0xffff0000, v119
    s_and_b32 s66, s3, 1
    s_lshl_b32 s67, s66, 14
    v_add_u32 v13, s67, v4
    v_add_u32 v3, 65536, v13
    v_and_b32 v10, 31, v0
    v_mov_b32 v8, v125
    v_mov_b32 v9, v126
    s_lshl1_add_u32 s71, s48, s66
    s_bfe_u32 s67, s3, 0x10001
    s_lshl1_add_u32 s72, s49, s67
    s_lshl_b32 s73, s71, 12
    s_add_u32 s73, s73, 0xdc0000
    v_lshlrev_b32 v12, 4, v10
    s_lshl_b32 s74, s49, 9
    s_lshl3_add_u32 s74, s67, s74
    s_add_u32 s74, s74, s73
    s_lshl_b32 s75, s67, 12
    s_lshl_b32 s66, s66, 10
    s_add_u32 s75, s75, s66
    s_add_u32 s75, s75, 106496
    v_and_b32 v2, 7, v0
    s_and_b32 s66, s3, 0
    s_lshl2_add_u32 s66, s66, 98304
    v_lshl_add_u32 v2, v2, 2, s66
    s_lshl2_add_u32 s66, s3, 98416
    v_mov_b32 v14, s66
    s_waitcnt vmcnt(1) lgkmcnt(0)
    s_barrier
    ds_read_b32 v1, v2
    s_waitcnt lgkmcnt(0)
P3_c0:
    v_cmp_eq_u32 vcc, 0, v1
    s_bitcmp1_b32 vcc_lo, 0
    s_cbranch_scc1 P3_w0
P3_d0:
    ds_read_b128 v[96:99], v3 offset:0
    ds_read_b32 v1, v2
    ds_read_b128 v[100:103], v3 offset:1024
    ds_read_b128 v[104:107], v3 offset:2048
    ds_read_b128 v[108:111], v3 offset:3072
    s_waitcnt lgkmcnt(4)
    v_mfma_f32_32x32x16_bf16 v[16:31], v[32:35], v[96:99], v[16:31]
    s_waitcnt lgkmcnt(3)
P3_c1:
    v_cmp_eq_u32 vcc, 0, v1
    s_bitcmp1_b32 vcc_lo, 1
    s_cbranch_scc1 P3_w1
P3_d1:
    ds_read_b128 v[112:115], v3 offset:4096
    ds_read_b128 v[116:119], v3 offset:5120
    ds_read_b64_tr_b16 v[32:33], v5 offset:32768
    ds_read_b64_tr_b16 v[34:35], v5 offset:33792
    s_waitcnt lgkmcnt(6)
    v_mfma_f32_32x32x16_bf16 v[16:31], v[36:39], v[100:103], v[16:31]
    ds_read_b128 v[120:123], v3 offset:6144
    ds_read_b128 v[124:127], v3 offset:7168
    ds_read_b64_tr_b16 v[36:37], v5 offset:34816
    ds_read_b64_tr_b16 v[38:39], v5 offset:35840
    s_waitcnt lgkmcnt(9)
    v_mfma_f32_32x32x16_bf16 v[16:31], v[40:43], v[104:107], v[16:31]
    ds_read_b32 v1, v2
    ds_read_b64_tr_b16 v[40:41], v5 offset:36864
    ds_read_b64_tr_b16 v[42:43], v5 offset:37888
    s_waitcnt lgkmcnt(11)
    v_mfma_f32_32x32x16_bf16 v[16:31], v[44:47], v[108:111], v[16:31]
    ds_read_b64_tr_b16 v[44:45], v5 offset:38912
    ds_read_b64_tr_b16 v[46:47], v5 offset:39936
    s_waitcnt lgkmcnt(12)
    v_mfma_f32_32x32x16_bf16 v[16:31], v[48:51], v[112:115], v[16:31]
    s_waitcnt lgkmcnt(4)
P3_c2:
    v_cmp_eq_u32 vcc, 0, v1
    s_bitcmp1_b32 vcc_lo, 2
    s_cbranch_scc1 P3_w2
P3_d2:
    ds_read_b128 v[96:99], v3 offset:8192
    ds_read_b128 v[100:103], v3 offset:9216
    ds_read_b64_tr_b16 v[48:49], v5 offset:40960
    ds_read_b64_tr_b16 v[50:51], v5 offset:41984
    v_mfma_f32_32x32x16_bf16 v[16:31], v[52:55], v[116:119], v[16:31]
    ds_read_b128 v[104:107], v3 offset:10240
    ds_read_b128 v[108:111], v3 offset:11264
    ds_read_b64_tr_b16 v[52:53], v5 offset:43008
    ds_read_b64_tr_b16 v[54:55], v5 offset:44032
    v_mfma_f32_32x32x16_bf16 v[16:31], v[56:59], v[120:123], v[16:31]
    ds_read_b32 v1, v2
    ds_read_b64_tr_b16 v[56:57], v5 offset:45056
    ds_read_b64_tr_b16 v[58:59], v5 offset:46080
    v_mfma_f32_32x32x16_bf16 v[16:31], v[60:63], v[124:127], v[16:31]
    ds_read_b64_tr_b16 v[60:61], v5 offset:47104
    ds_read_b64_tr_b16 v[62:63], v5 offset:48128
    s_waitcnt lgkmcnt(12)
    v_mfma_f32_32x32x16_bf16 v[16:31], v[64:67], v[96:99], v[16:31]
    s_waitcnt lgkmcnt(4)
P3_c3:
    v_cmp_eq_u32 vcc, 0, v1
    s_bitcmp1_b32 vcc_lo, 3
    s_cbranch_scc1 P3_w3
P3_d3:
    ds_read_b128 v[112:115], v3 offset:12288
    ds_read_b128 v[116:119], v3 offset:13312
    ds_read_b64_tr_b16 v[64:65], v5 offset:49152
    ds_read_b64_tr_b16 v[66:67], v5 offset:50176
    v_mfma_f32_32x32x16_bf16 v[16:31], v[68:71], v[100:103], v[16:31]
    ds_read_b128 v[120:123], v3 offset:14336
    ds_read_b128 v[124:127], v3 offset:15360
    ds_read_b64_tr_b16 v[68:69], v5 offset:51200
    ds_read_b64_tr_b16 v[70:71], v5 offset:52224
    ds_write_b32 v14, v14
    v_mfma_f32_32x32x16_bf16 v[16:31], v[72:75], v[104:107], v[16:31]
    ds_read_b32 v1, v2
    ds_read_b64_tr_b16 v[72:73], v5 offset:53248
    ds_read_b64_tr_b16 v[74:75], v5 offset:54272
    v_mfma_f32_32x32x16_bf16 v[16:31], v[76:79], v[108:111], v[16:31]
    ds_read_b64_tr_b16 v[76:77], v5 offset:55296
    ds_read_b64_tr_b16 v[78:79], v5 offset:56320
    s_waitcnt lgkmcnt(13)
    v_mfma_f32_32x32x16_bf16 v[16:31], v[80:83], v[112:115], v[16:31]
    s_waitcnt lgkmcnt(4)
P3_c4:
    v_cmp_eq_u32 vcc, 0, v1
    s_bitcmp1_b32 vcc_lo, 4
    s_cbranch_scc1 P3_w4
P3_d4:
    ds_read_b128 v[96:99], v13 offset:0
    ds_read_b128 v[100:103], v13 offset:1024
    ds_read_b64_tr_b16 v[80:81], v5 offset:57344
    ds_read_b64_tr_b16 v[82:83], v5 offset:58368
    v_mfma_f32_32x32x16_bf16 v[16:31], v[84:87], v[116:119], v[16:31]
    ds_read_b128 v[104:107], v13 offset:2048
    ds_read_b128 v[108:111], v13 offset:3072
    ds_read_b64_tr_b16 v[84:85], v5 offset:59392
    ds_read_b64_tr_b16 v[86:87], v5 offset:60416
    v_mfma_f32_32x32x16_bf16 v[16:31], v[88:91], v[120:123], v[16:31]
    ds_read_b32 v1, v2
    ds_read_b64_tr_b16 v[88:89], v5 offset:61440
    ds_read_b64_tr_b16 v[90:91], v5 offset:62464
    v_mfma_f32_32x32x16_bf16 v[16:31], v[92:95], v[124:127], v[16:31]
    ds_read_b64_tr_b16 v[92:93], v5 offset:63488
    ds_read_b64_tr_b16 v[94:95], v5 offset:64512
    ds_write_b32 v14, v14 offset:16
    s_waitcnt lgkmcnt(13)
    v_mfma_f32_32x32x16_bf16 v[16:31], v[32:35], v[96:99], v[16:31]
    s_waitcnt lgkmcnt(5)
P3_c5:
    v_cmp_eq_u32 vcc, 0, v1
    s_bitcmp1_b32 vcc_lo, 5
    s_cbranch_scc1 P3_w5
P3_d5:
    ds_read_b128 v[112:115], v13 offset:4096
    ds_read_b128 v[116:119], v13 offset:5120
    v_mfma_f32_32x32x16_bf16 v[16:31], v[36:39], v[100:103], v[16:31]
    ds_read_b128 v[120:123], v13 offset:6144
    ds_read_b128 v[124:127], v13 offset:7168
    v_mfma_f32_32x32x16_bf16 v[16:31], v[40:43], v[104:107], v[16:31]
    ds_read_b32 v1, v2
    v_mfma_f32_32x32x16_bf16 v[16:31], v[44:47], v[108:111], v[16:31]
    s_waitcnt lgkmcnt(4)
    v_mfma_f32_32x32x16_bf16 v[16:31], v[48:51], v[112:115], v[16:31]
    s_waitcnt lgkmcnt(0)
P3_c6:
    v_cmp_eq_u32 vcc, 0, v1
    s_bitcmp1_b32 vcc_lo, 6
    s_cbranch_scc1 P3_w6
P3_d6:
    ds_read_b128 v[96:99], v13 offset:8192
    ds_read_b128 v[100:103], v13 offset:9216
    v_mfma_f32_32x32x16_bf16 v[16:31], v[52:55], v[116:119], v[16:31]
    ds_read_b128 v[104:107], v13 offset:10240
    ds_read_b128 v[108:111], v13 offset:11264
    v_mfma_f32_32x32x16_bf16 v[16:31], v[56:59], v[120:123], v[16:31]
    ds_read_b32 v1, v2
    v_mfma_f32_32x32x16_bf16 v[16:31], v[60:63], v[124:127], v[16:31]
    s_waitcnt lgkmcnt(4)
    v_mfma_f32_32x32x16_bf16 v[16:31], v[64:67], v[96:99], v[16:31]
    s_waitcnt lgkmcnt(0)
P3_c7:
    v_cmp_eq_u32 vcc, 0, v1
    s_bitcmp1_b32 vcc_lo, 7
    s_cbranch_scc1 P3_w7
P3_d7:
    ds_read_b128 v[112:115], v13 offset:12288
    ds_read_b128 v[116:119], v13 offset:13312
    v_mfma_f32_32x32x16_bf16 v[16:31], v[68:71], v[100:103], v[16:31]
    ds_read_b128 v[120:123], v13 offset:14336
    ds_read_b128 v[124:127], v13 offset:15360
    v_mfma_f32_32x32x16_bf16 v[16:31], v[72:75], v[104:107], v[16:31]
    v_mfma_f32_32x32x16_bf16 v[16:31], v[76:79], v[108:111], v[16:31]
    s_waitcnt lgkmcnt(3)
    v_mfma_f32_32x32x16_bf16 v[16:31], v[80:83], v[112:115], v[16:31]
    s_waitcnt lgkmcnt(2)
    v_mfma_f32_32x32x16_bf16 v[16:31], v[84:87], v[116:119], v[16:31]
    s_waitcnt lgkmcnt(1)
    v_mfma_f32_32x32x16_bf16 v[16:31], v[88:91], v[120:123], v[16:31]
    s_waitcnt lgkmcnt(0)
    v_mfma_f32_32x32x16_bf16 v[16:31], v[92:95], v[124:127], v[16:31]
    v_and_b32 v15, 15, v0
    v_lshlrev_b32 v15, 4, v15
    v_bfe_u32 v14, v0, 4, 1
    v_lshl_add_u32 v15, v14, 9, v15
    v_lshl_add_u32 v15, v11, 11, v15
    v_add_u32 v15, s75, v15
    v_lshl_add_u32 v13, v11, 11, v12
    s_cmp_lg_u32 s0, 0
    s_nop 3
    v_pk_add_f32 v[6:7], v[16:17], v[18:19]
    v_pk_mul_f32 v[2:3], v[16:17], v[16:17]
    v_pk_fma_f32 v[2:3], v[18:19], v[18:19], v[2:3]
    v_pk_add_f32 v[6:7], v[6:7], v[20:21]
    v_pk_fma_f32 v[2:3], v[20:21], v[20:21], v[2:3]
    v_pk_add_f32 v[6:7], v[6:7], v[22:23]
    v_pk_fma_f32 v[2:3], v[22:23], v[22:23], v[2:3]
    v_pk_add_f32 v[6:7], v[6:7], v[24:25]
    v_pk_fma_f32 v[2:3], v[24:25], v[24:25], v[2:3]
    v_pk_add_f32 v[6:7], v[6:7], v[26:27]
    v_pk_fma_f32 v[2:3], v[26:27], v[26:27], v[2:3]
    v_pk_add_f32 v[6:7], v[6:7], v[28:29]
    v_pk_fma_f32 v[2:3], v[28:29], v[28:29], v[2:3]
    v_pk_add_f32 v[6:7], v[6:7], v[30:31]
    v_pk_fma_f32 v[2:3], v[30:31], v[30:31], v[2:3]
    v_add_f32 v6, v6, v7
    v_add_f32 v7, v2, v3
    v_mov_b32 v2, v6
    v_mov_b32 v3, v7
    s_nop 0
    v_permlane32_swap_b32 v6, v2
    v_permlane32_swap_b32 v7, v3
    s_mov_b32 exec_hi, 0
    v_add_f32 v6, v6, v2
    v_add_f32 v7, v7, v3
    v_and_b32 v7, 0x7fffffff, v7
    s_cbranch_scc0 P3_sg
    buffer_store_dwordx2 v[6:7], v12, s[40:43], s74 offen
P3_se:
    s_mov_b32 exec_hi, -1
    buffer_load_dwordx4 v[48:51], v13, s[40:43], s73 offen offset:0 sc1
    buffer_load_dwordx4 v[52:55], v13, s[40:43], s73 offen offset:512 sc1
    buffer_load_dwordx4 v[56:59], v13, s[40:43], s73 offen offset:1024 sc1
    buffer_load_dwordx4 v[60:63], v13, s[40:43], s73 offen offset:1536 sc1
    v_lshrrev_b32 v121, 4, v0
    v_bfe_u32 v122, v0, 2, 2
    v_lshl_add_u32 v120, v121, 3, v122
    v_lshlrev_b32 v120, 7, v120
    v_bfe_u32 v121, v0, 3, 2
    v_lshl_add_u32 v120, v121, 5, v120
    v_and_b32 v121, 3, v0
    v_lshl_add_u32 v120, v121, 3, v120
    v_add_u32 v120, s57, v120
    v_xor_b32 v121, 32, v120
    v_xor_b32 v122, 64, v120
    v_xor_b32 v123, 96, v120
    ds_read_b64_tr_b16 v[64:65], v120 offset:0
    ds_read_b64_tr_b16 v[66:67], v120 offset:512
    ds_read_b64_tr_b16 v[68:69], v121 offset:0
    ds_read_b64_tr_b16 v[70:71], v121 offset:512
    ds_read_b64_tr_b16 v[72:73], v122 offset:0
    ds_read_b64_tr_b16 v[74:75], v122 offset:512
    ds_read_b64_tr_b16 v[76:77], v123 offset:0
    ds_read_b64_tr_b16 v[78:79], v123 offset:512
    v_cvt_pk_bf16_f32 v32, v16, v17
    v_cvt_pk_bf16_f32 v33, v18, v19
    v_cvt_pk_bf16_f32 v34, v20, v21
    v_cvt_pk_bf16_f32 v35, v22, v23
    v_cvt_pk_bf16_f32 v36, v24, v25
    v_cvt_pk_bf16_f32 v37, v26, v27
    v_cvt_pk_bf16_f32 v38, v28, v29
    v_cvt_pk_bf16_f32 v39, v30, v31
    ds_write_b128 v15, v[32:35]
    ds_write_b128 v15, v[36:39] offset:256
    v_lshlrev_b32 v1, 6, v10
    v_lshl_add_u32 v1, v11, 5, v1
    v_add_u32 v1, s57, v1
    v_lshrrev_b32 v5, 2, v0
    v_lshlrev_b32 v5, 6, v5
    v_and_b32 v14, 3, v0
    v_lshl_add_u32 v5, v14, 3, v5
    v_add_u32 v5, s57, v5
    s_lshl_b32 s74, s72, 17
    s_lshl_b32 s67, s71, 10
    s_add_u32 s74, s74, s67
    s_add_u32 s74, s74, 0xa00000
    s_add_u32 s75, s74, 0x10000
    s_mov_b32 s66, 0x3b000000
    s_mov_b32 s67, 0x3f800054
    v_mov_b32 v14, 0x2edbe6ff
    s_branch P3_chk
P3_poll:
    buffer_load_dwordx4 v[48:51], v13, s[40:43], s73 offen offset:0 sc1
    buffer_load_dwordx4 v[52:55], v13, s[40:43], s73 offen offset:512 sc1
    buffer_load_dwordx4 v[56:59], v13, s[40:43], s73 offen offset:1024 sc1
    buffer_load_dwordx4 v[60:63], v13, s[40:43], s73 offen offset:1536 sc1
P3_chk:
    s_waitcnt vmcnt(0)
    v_or3_b32 v6, v49, v51, v53
    v_or3_b32 v7, v55, v57, v59
    v_or3_b32 v6, v6, v61, v63
    v_or_b32 v6, v6, v7
    v_cmp_gt_i32 vcc, 0, v6
    v_pk_add_f32 v[6:7], v[48:49], v[50:51]
    v_pk_add_f32 v[2:3], v[52:53], v[54:55]
    s_cbranch_vccz P3_poll_ok
    s_sub_u32 s52, s52, 1
    s_cbranch_scc0 P3_poll
    s_mov_b32 s52, 0
P3_poll_ok:
    v_pk_add_f32 v[6:7], v[6:7], v[56:57]
    v_pk_add_f32 v[2:3], v[2:3], v[58:59]
    v_pk_add_f32 v[6:7], v[6:7], v[60:61]
    v_pk_add_f32 v[2:3], v[2:3], v[62:63]
    v_pk_add_f32 v[6:7], v[6:7], v[2:3]
    v_mov_b32 v2, v6
    v_mov_b32 v3, v7
    s_nop 0
    v_permlane32_swap_b32 v6, v2
    v_permlane32_swap_b32 v7, v3
    s_nop 0
    v_add_f32 v6, v6, v2
    v_add_f32 v7, v7, v3
    v_mul_f32 v6, s66, v6
    v_mul_f32 v7, s66, v7
    v_fma_f32 v7, -v6, v6, v7
    v_max_f32 v7, 0, v7
    v_fma_f32 v7, v7, s67, v14
    v_rsq_f32 v2, v7
    s_nop 0
    v_mul_f32 v3, v6, v2
    v_pk_fma_f32 v[16:17], v[16:17], v[2:3], v[2:3] op_sel:[0,0,1] op_sel_hi:[1,0,1] neg_lo:[0,0,1] neg_hi:[0,0,1]
    v_pk_fma_f32 v[18:19], v[18:19], v[2:3], v[2:3] op_sel:[0,0,1] op_sel_hi:[1,0,1] neg_lo:[0,0,1] neg_hi:[0,0,1]
    v_pk_fma_f32 v[20:21], v[20:21], v[2:3], v[2:3] op_sel:[0,0,1] op_sel_hi:[1,0,1] neg_lo:[0,0,1] neg_hi:[0,0,1]
    v_pk_fma_f32 v[22:23], v[22:23], v[2:3], v[2:3] op_sel:[0,0,1] op_sel_hi:[1,0,1] neg_lo:[0,0,1] neg_hi:[0,0,1]
    v_cvt_pk_bf16_f32 v48, v16, v17
    v_cvt_pk_bf16_f32 v49, v18, v19
    v_cvt_pk_bf16_f32 v50, v20, v21
    v_cvt_pk_bf16_f32 v51, v22, v23
    ds_write_b128 v1, v[48:51] offset:0
    v_pk_fma_f32 v[24:25], v[24:25], v[2:3], v[2:3] op_sel:[0,0,1] op_sel_hi:[1,0,1] neg_lo:[0,0,1] neg_hi:[0,0,1]
    v_pk_fma_f32 v[26:27], v[26:27], v[2:3], v[2:3] op_sel:[0,0,1] op_sel_hi:[1,0,1] neg_lo:[0,0,1] neg_hi:[0,0,1]
    v_pk_fma_f32 v[28:29], v[28:29], v[2:3], v[2:3] op_sel:[0,0,1] op_sel_hi:[1,0,1] neg_lo:[0,0,1] neg_hi:[0,0,1]
    v_pk_fma_f32 v[30:31], v[30:31], v[2:3], v[2:3] op_sel:[0,0,1] op_sel_hi:[1,0,1] neg_lo:[0,0,1] neg_hi:[0,0,1]
    v_cvt_pk_bf16_f32 v52, v24, v25
    v_cvt_pk_bf16_f32 v53, v26, v27
    v_cvt_pk_bf16_f32 v54, v28, v29
    v_cvt_pk_bf16_f32 v55, v30, v31
    ds_write_b128 v1, v[52:55] offset:16
    ds_read_b64_tr_b16 v[56:57], v5 offset:0
    ds_read_b64_tr_b16 v[58:59], v5 offset:1024
    ds_read_b64_tr_b16 v[60:61], v5 offset:32
    ds_read_b64_tr_b16 v[62:63], v5 offset:1056
    s_waitcnt lgkmcnt(2)
    buffer_store_dwordx4 v[56:59], v4, s[40:43], s74 offen sc1
    s_waitcnt lgkmcnt(0)
    buffer_store_dwordx4 v[60:63], v4, s[40:43], s75 offen sc1
    s_branch P3_done
P3_relay:
    v_lshrrev_b32 v121, 4, v0
    v_bfe_u32 v122, v0, 2, 2
    v_lshl_add_u32 v120, v121, 3, v122
    v_lshlrev_b32 v120, 7, v120
    v_bfe_u32 v121, v0, 3, 2
    v_lshl_add_u32 v120, v121, 5, v120
    v_and_b32 v121, 3, v0
    v_lshl_add_u32 v120, v121, 3, v120
    v_add_u32 v120, s57, v120
    v_xor_b32 v121, 32, v120
    v_xor_b32 v122, 64, v120
    v_xor_b32 v123, 96, v120
    s_waitcnt vmcnt(1)
    ds_read_b64_tr_b16 v[64:65], v120 offset:0
    ds_read_b64_tr_b16 v[66:67], v120 offset:512
    ds_read_b64_tr_b16 v[68:69], v121 offset:0
    ds_read_b64_tr_b16 v[70:71], v121 offset:512
    ds_read_b64_tr_b16 v[72:73], v122 offset:0
    ds_read_b64_tr_b16 v[74:75], v122 offset:512
    ds_read_b64_tr_b16 v[76:77], v123 offset:0
    ds_read_b64_tr_b16 v[78:79], v123 offset:512
    v_add_u32 v10, s86, v4
    v_add_u32 v3, 65536, v10
    s_lshl2_add_u32 s66, s3, 98304
    v_mov_b32 v2, s66
    v_mov_b32 v7, 0
    v_lshl_add_u32 v1, v0, 2, s57
    ds_write_b32 v1, v7
    v_mov_b32 v8, v125
    v_mov_b32 v9, v126
    v_mov_b32 v7, 1
    v_add_u32 v5, 32768, v4
    s_lshl_b32 s66, s3, 2
    s_lshr_b32 s66, 0x64302571, s66
    s_bfe_u32 s67, s66, 0x30010
    s_and_b32 s66, s66, 7
    s_lshl4_add_u32 s71, s48, s66
    s_lshl4_add_u32 s72, s48, s67
    s_lshl_b32 s71, s71, 12
    s_lshl_b32 s72, s72, 12
    s_add_u32 s71, s71, 0x800000
    s_add_u32 s72, s72, 0x800000
    s_mov_b32 s73, 3
    s_waitcnt lgkmcnt(0)
    s_barrier
R_round:
    s_bitcmp1_b32 s73, 0
    s_cbranch_scc0 R_p0
    buffer_load_dwordx4 v[48:51], v4, s[40:43], s71 offen offset:0 sc1
    buffer_load_dwordx4 v[52:55], v4, s[40:43], s71 offen offset:1024 sc1
    buffer_load_dwordx4 v[56:59], v4, s[40:43], s71 offen offset:2048 sc1
    buffer_load_dwordx4 v[60:63], v4, s[40:43], s71 offen offset:3072 sc1
    buffer_load_dwordx4 v[80:83], v5, s[40:43], s71 offen offset:0 sc1
    buffer_load_dwordx4 v[84:87], v5, s[40:43], s71 offen offset:1024 sc1
    buffer_load_dwordx4 v[88:91], v5, s[40:43], s71 offen offset:2048 sc1
    buffer_load_dwordx4 v[92:95], v5, s[40:43], s71 offen offset:3072 sc1
R_p0:
    s_bitcmp1_b32 s73, 1
    s_cbranch_scc0 R_p1
    buffer_load_dwordx4 v[96:99], v4, s[40:43], s72 offen offset:0 sc1
    buffer_load_dwordx4 v[100:103], v4, s[40:43], s72 offen offset:1024 sc1
    buffer_load_dwordx4 v[112:115], v4, s[40:43], s72 offen offset:2048 sc1
    buffer_load_dwordx4 v[116:119], v4, s[40:43], s72 offen offset:3072 sc1
    buffer_load_dwordx4 v[32:35], v5, s[40:43], s72 offen offset:0 sc1
    buffer_load_dwordx4 v[36:39], v5, s[40:43], s72 offen offset:1024 sc1
    buffer_load_dwordx4 v[40:43], v5, s[40:43], s72 offen offset:2048 sc1
    buffer_load_dwordx4 v[44:47], v5, s[40:43], s72 offen offset:3072 sc1
R_p1:
    s_cmp_eq_u32 s73, 3
    s_waitcnt vmcnt(8)
    s_cbranch_scc1 R_fl0
    s_waitcnt vmcnt(0)
R_fl0:
    s_bitcmp1_b32 s73, 0
    s_cbranch_scc0 R_fl1
    v_max3_u32 v1, v51, v55, v59
    v_max3_u32 v11, v63, v83, v87
    v_max3_u32 v1, v1, v91, v95
    v_max_u32 v1, v1, v11
    v_cmp_eq_u32 vcc, -1, v1
    s_cbranch_vccnz R_fl1
    ds_write_b128 v3, v[48:51] offset:0
    ds_write_b128 v3, v[52:55] offset:1024
    ds_write_b128 v3, v[56:59] offset:2048
    ds_write_b128 v3, v[60:63] offset:3072
    ds_write_b128 v3, v[80:83] offset:16384
    ds_write_b128 v3, v[84:87] offset:17408
    ds_write_b128 v3, v[88:91] offset:18432
    ds_write_b128 v3, v[92:95] offset:19456
    s_bitset0_b32 s73, 0
    ds_write_b32 v2, v7 offset:0
R_fl1:
    s_bitcmp1_b32 s73, 1
    s_cbranch_scc0 R_fl2
    s_waitcnt vmcnt(0)
    v_max3_u32 v1, v99, v103, v115
    v_max3_u32 v11, v119, v35, v39
    v_max3_u32 v1, v1, v43, v47
    v_max_u32 v1, v1, v11
    v_cmp_eq_u32 vcc, -1, v1
    s_cbranch_vccnz R_fl2
    ds_write_b128 v10, v[96:99] offset:0
    ds_write_b128 v10, v[100:103] offset:1024
    ds_write_b128 v10, v[112:115] offset:2048
    ds_write_b128 v10, v[116:119] offset:3072
    ds_write_b128 v10, v[32:35] offset:16384
    ds_write_b128 v10, v[36:39] offset:17408
    ds_write_b128 v10, v[40:43] offset:18432
    ds_write_b128 v10, v[44:47] offset:19456
    s_bitset0_b32 s73, 1
    ds_write_b32 v2, v7 offset:16
R_fl2:
    s_cmp_lg_u32 s73, 0
    s_cbranch_scc0 R_done
    s_sub_u32 s52, s52, 1
    s_cbranch_scc0 R_round
    s_mov_b32 s52, 0
R_done:
    s_add_u32 s71, s85, 3670016
    s_add_u32 s72, s86, 16384
    v_and_b32 v2, 3, v0
    v_lshlrev_b32 v2, 2, v2
    v_add_u32 v2, 98432, v2
R_h0:
    ds_read_b32 v1, v2 offset:0
    s_waitcnt lgkmcnt(0)
    v_cmp_eq_u32 vcc, 0, v1
    s_cbranch_vccz R_h0_ok
    s_sub_u32 s52, s52, 1
    s_cbranch_scc0 R_h0
    s_mov_b32 s52, 0
R_h0_ok:
    s_add_u32 m0, s72, 65536
    s_add_u32 s66, s71, 524288
    buffer_load_dwordx4 v8, s[24:27], s66 offen offset:0 lds
    buffer_load_dwordx4 v9, s[24:27], s66 offen offset:1024 lds
    s_add_u32 m0, s72, 67584
    s_add_u32 s66, s71, 589824
    buffer_load_dwordx4 v8, s[24:27], s66 offen offset:0 lds
    buffer_load_dwordx4 v9, s[24:27], s66 offen offset:1024 lds
    s_add_u32 m0, s86, 65536
    s_add_u32 s66, s85, 524288
    buffer_load_dwordx4 v8, s[24:27], s66 offen offset:0 lds
    buffer_load_dwordx4 v9, s[24:27], s66 offen offset:1024 lds
    s_add_u32 m0, s86, 67584
    s_add_u32 s66, s85, 589824
    buffer_load_dwordx4 v8, s[24:27], s66 offen offset:0 lds
    buffer_load_dwordx4 v9, s[24:27], s66 offen offset:1024 lds
R_h1:
    ds_read_b32 v1, v2 offset:16
    s_waitcnt lgkmcnt(0)
    v_cmp_eq_u32 vcc, 0, v1
    s_cbranch_vccz R_h1_ok
    s_sub_u32 s52, s52, 1
    s_cbranch_scc0 R_h1
    s_mov_b32 s52, 0
R_h1_ok:
    s_add_u32 m0, s72, 32768
    s_add_u32 s66, s71, 393216
    buffer_load_dwordx4 v8, s[24:27], s66 offen offset:0 lds
    buffer_load_dwordx4 v9, s[24:27], s66 offen offset:1024 lds
    s_add_u32 m0, s72, 34816
    s_add_u32 s66, s71, 458752
    buffer_load_dwordx4 v8, s[24:27], s66 offen offset:0 lds
    buffer_load_dwordx4 v9, s[24:27], s66 offen offset:1024 lds
    s_add_u32 m0, s86, 32768
    s_add_u32 s66, s85, 393216
    buffer_load_dwordx4 v8, s[24:27], s66 offen offset:0 lds
    buffer_load_dwordx4 v9, s[24:27], s66 offen offset:1024 lds
    s_add_u32 m0, s86, 34816
    s_add_u32 s66, s85, 458752
    buffer_load_dwordx4 v8, s[24:27], s66 offen offset:0 lds
    buffer_load_dwordx4 v9, s[24:27], s66 offen offset:1024 lds
    s_waitcnt vmcnt(0) lgkmcnt(0)
P3_done:
    s_barrier
    ds_read_b64_tr_b16 v[80:81], v120 offset:32768
    ds_read_b64_tr_b16 v[82:83], v120 offset:33280
    ds_read_b64_tr_b16 v[84:85], v121 offset:32768
    ds_read_b64_tr_b16 v[86:87], v121 offset:33280
    ds_read_b64_tr_b16 v[88:89], v122 offset:32768
    ds_read_b64_tr_b16 v[90:91], v122 offset:33280
    ds_read_b64_tr_b16 v[92:93], v123 offset:32768
    ds_read_b64_tr_b16 v[94:95], v123 offset:33280
    v_lshlrev_b32 v3, 2, v0
    s_lshl_b32 s66, s3, 8
    s_add_u32 s66, s66, 106496
    v_add_u32 v1, s66, v3
    ds_read_b32 v116, v1 offset:0
    ds_read_b32 v117, v1 offset:2048
    ds_read_b32 v118, v1 offset:4096
    ds_read_b32 v119, v1 offset:6144
    v_and_b32 v11, 3, v0
    v_lshlrev_b32 v1, 2, v11
    v_lshrrev_b32 v10, 2, v0
    v_lshlrev_b32 v2, 1, v10
    buffer_load_dword v113, v1, s[20:23], s87 offen
    buffer_load_ushort v114, v2, s[28:31], s88 offen
    v_bfe_u32 v1, v0, 4, 1
    v_lshlrev_b32 v1, 3, v1
    v_xor_b32 v1, v1, v0
    v_lshl_add_u32 v6, v1, 4, s57
    v_bfe_u32 v1, v0, 1, 1
    v_mul_u32_u24 v1, 24, v1
    v_xor_b32 v1, v1, v10
    v_lshlrev_b32 v1, 4, v1
    v_and_b32 v2, 1, v0
    v_lshl_add_u32 v1, v2, 3, v1
    s_lshl_b32 s66, s3, 9
    s_add_u32 s66, s66, 98304
    v_add_u32 v7, s66, v1
    v_lshl_add_u32 v3, v11, 28, v3
    s_lshl_b32 s72, s51, 5
    s_add_u32 s72, s72, s81
    s_lshl_b32 s72, s72, 13
    s_add_u32 s72, s72, 0xa00000
    s_add_u32 s73, s72, 4096
    s_mul_i32 s74, s49, 229376
    s_mul_i32 s66, s3, 7168
    s_add_u32 s74, s74, s66
    s_add_u32 s74, s74, 0xc00000
    s_add_u32 s75, s74, 4096
    s_mul_i32 s76, s51, 229376
    s_lshl4_add_u32 s76, s87, s76
    s_add_u32 s76, s76, 0xc00000
    v_lshlrev_b32 v10, 10, v10
    v_lshl_add_u32 v10, v11, 2, v10
    s_lshl_b32 s66, s88, 9
    s_lshl_b32 s67, s49, 7
    s_add_u32 s66, s66, s67
    s_and_b32 s67, s3, 1
    s_lshl4_add_u32 s66, s67, s66
    v_add_u32 v10, s66, v10
    v_mov_b32 v115, 0xc0135761
    s_mov_b32 s77, 0xbdd2d3e8
    v_subrev_u32 v12, 98304, v120
    v_subrev_u32 v13, 98304, v121
    v_subrev_u32 v14, 98304, v122
    v_subrev_u32 v15, 98304, v123
    s_waitcnt lgkmcnt(0)
    s_cmp_ge_u32 s45, 28
    s_cbranch_scc1 P4_idle
    v_add_u32 v124, 0, v4
    buffer_load_dwordx4 v[32:35], v124, s[40:43], s72 offen offset:0 sc1
    buffer_load_dwordx4 v[36:39], v124, s[40:43], s72 offen offset:1024 sc1
    buffer_load_dwordx4 v[40:43], v124, s[40:43], s72 offen offset:2048 sc1
    buffer_load_dwordx4 v[44:47], v124, s[40:43], s72 offen offset:3072 sc1
    buffer_load_dwordx4 v[48:51], v124, s[40:43], s73 offen offset:0 sc1
    buffer_load_dwordx4 v[52:55], v124, s[40:43], s73 offen offset:1024 sc1
    buffer_load_dwordx4 v[56:59], v124, s[40:43], s73 offen offset:2048 sc1
    buffer_load_dwordx4 v[60:63], v124, s[40:43], s73 offen offset:3072 sc1
    s_waitcnt vmcnt(8)
    v_lshlrev_b32 v112, 16, v113
    v_and_b32 v113, 0xffff0000, v113
    v_lshlrev_b32 v114, 16, v114
    s_waitcnt vmcnt(7)
    v_cmp_eq_u32 vcc, -1, v35
    s_cbranch_vccnz G_c0_r
G_c0:
    v_mfma_f32_16x16x32_bf16 v[16:19], a[0:3], v[32:35], 0
    v_mfma_f32_16x16x32_bf16 v[20:23], a[4:7], v[32:35], 0
    s_waitcnt vmcnt(6)
    v_cmp_eq_u32 vcc, -1, v39
    v_mfma_f32_16x16x32_bf16 v[24:27], a[8:11], v[32:35], 0
    v_mfma_f32_16x16x32_bf16 v[28:31], a[12:15], v[32:35], 0
    v_add_u32 v125, 65536, v4
    buffer_load_dwordx4 v[32:35], v125, s[40:43], s72 offen offset:0 sc1
    s_cbranch_vccnz G_c1_r
G_c1:
    v_mfma_f32_16x16x32_bf16 v[16:19], a[16:19], v[36:39], v[16:19]
    v_mfma_f32_16x16x32_bf16 v[20:23], a[20:23], v[36:39], v[20:23]
    s_waitcnt vmcnt(6)
    v_cmp_eq_u32 vcc, -1, v43
    v_mfma_f32_16x16x32_bf16 v[24:27], a[24:27], v[36:39], v[24:27]
    v_mfma_f32_16x16x32_bf16 v[28:31], a[28:31], v[36:39], v[28:31]
    buffer_load_dwordx4 v[36:39], v125, s[40:43], s72 offen offset:1024 sc1
    s_cbranch_vccnz G_c2_r
G_c2:
    v_mfma_f32_16x16x32_bf16 v[16:19], a[32:35], v[40:43], v[16:19]
    v_mfma_f32_16x16x32_bf16 v[20:23], a[36:39], v[40:43], v[20:23]
    s_waitcnt vmcnt(6)
    v_cmp_eq_u32 vcc, -1, v47
    v_mfma_f32_16x16x32_bf16 v[24:27], a[40:43], v[40:43], v[24:27]
    v_mfma_f32_16x16x32_bf16 v[28:31], a[44:47], v[40:43], v[28:31]
    buffer_load_dwordx4 v[40:43], v125, s[40:43], s72 offen offset:2048 sc1
    s_cbranch_vccnz G_c3_r
G_c3:
    v_mfma_f32_16x16x32_bf16 v[16:19], a[48:51], v[44:47], v[16:19]
    v_mfma_f32_16x16x32_bf16 v[20:23], a[52:55], v[44:47], v[20:23]
    s_waitcnt vmcnt(6)
    v_cmp_eq_u32 vcc, -1, v51
    v_mfma_f32_16x16x32_bf16 v[24:27], a[56:59], v[44:47], v[24:27]
    v_mfma_f32_16x16x32_bf16 v[28:31], a[60:63], v[44:47], v[28:31]
    buffer_load_dwordx4 v[44:47], v125, s[40:43], s72 offen offset:3072 sc1
    s_cbranch_vccnz G_c4_r
G_c4:
    v_mfma_f32_16x16x32_bf16 v[16:19], a[64:67], v[48:51], v[16:19]
    v_mfma_f32_16x16x32_bf16 v[20:23], a[68:71], v[48:51], v[20:23]
    s_waitcnt vmcnt(6)
    v_cmp_eq_u32 vcc, -1, v55
    s_add_u32 m0, s86, 0
    s_add_u32 s68, s85, 262144
    v_mfma_f32_16x16x32_bf16 v[24:27], a[72:75], v[48:51], v[24:27]
    buffer_load_dwordx4 v8, s[24:27], s68 offen offset:0 lds
    v_mfma_f32_16x16x32_bf16 v[28:31], a[76:79], v[48:51], v[28:31]
    buffer_load_dwordx4 v[48:51], v125, s[40:43], s73 offen offset:0 sc1
    s_cbranch_vccnz G_c5_r
G_c5:
    v_mfma_f32_16x16x32_bf16 v[16:19], a[80:83], v[52:55], v[16:19]
    v_mfma_f32_16x16x32_bf16 v[20:23], a[84:87], v[52:55], v[20:23]
    s_waitcnt vmcnt(7)
    v_cmp_eq_u32 vcc, -1, v59
    v_mfma_f32_16x16x32_bf16 v[24:27], a[88:91], v[52:55], v[24:27]
    v_mfma_f32_16x16x32_bf16 v[28:31], a[92:95], v[52:55], v[28:31]
    buffer_load_dwordx4 v[52:55], v125, s[40:43], s73 offen offset:1024 sc1
    s_cbranch_vccnz G_c6_r
G_c6:
    v_mfma_f32_16x16x32_bf16 v[16:19], a[96:99], v[56:59], v[16:19]
    v_mfma_f32_16x16x32_bf16 v[20:23], a[100:103], v[56:59], v[20:23]
    s_waitcnt vmcnt(7)
    v_cmp_eq_u32 vcc, -1, v63
    v_mfma_f32_16x16x32_bf16 v[24:27], a[104:107], v[56:59], v[24:27]
    v_mfma_f32_16x16x32_bf16 v[28:31], a[108:111], v[56:59], v[28:31]
    buffer_load_dwordx4 v[56:59], v125, s[40:43], s73 offen offset:2048 sc1
    s_cbranch_vccnz G_c7_r
G_c7:
    v_mfma_f32_16x16x32_bf16 v[16:19], a[112:115], v[60:63], v[16:19]
    v_mfma_f32_16x16x32_bf16 v[20:23], a[116:119], v[60:63], v[20:23]
    s_waitcnt vmcnt(7)
    v_cmp_eq_u32 vcc, -1, v35
    v_mfma_f32_16x16x32_bf16 v[24:27], a[120:123], v[60:63], v[24:27]
    v_mfma_f32_16x16x32_bf16 v[28:31], a[124:127], v[60:63], v[28:31]
    buffer_load_dwordx4 v[60:63], v125, s[40:43], s73 offen offset:3072 sc1
    s_cbranch_vccnz G_c8_r
G_c8:
    v_mfma_f32_16x16x32_bf16 v[96:99], a[0:3], v[32:35], 0
    buffer_load_dwordx4 v9, s[24:27], s68 offen offset:1024 lds
    v_mfma_f32_16x16x32_bf16 v[100:103], a[4:7], v[32:35], 0
    s_waitcnt vmcnt(8)
    v_cmp_eq_u32 vcc, -1, v39
    ds_write_b128 v6, v[16:19] offset:32768
    v_mfma_f32_16x16x32_bf16 v[104:107], a[8:11], v[32:35], 0
    v_mfma_f32_16x16x32_bf16 v[108:111], a[12:15], v[32:35], 0
    v_add_u32 v124, 131072, v4
    buffer_load_dwordx4 v[32:35], v124, s[40:43], s72 offen offset:0 sc1
    ds_write_b128 v6, v[20:23] offset:33792
    s_cbranch_vccnz G_c9_r
G_c9:
    v_mfma_f32_16x16x32_bf16 v[96:99], a[16:19], v[36:39], v[96:99]
    v_mfma_f32_16x16x32_bf16 v[100:103], a[20:23], v[36:39], v[100:103]
    s_waitcnt vmcnt(8)
    v_cmp_eq_u32 vcc, -1, v43
    ds_write_b128 v6, v[24:27] offset:34816
    v_mfma_f32_16x16x32_bf16 v[104:107], a[24:27], v[36:39], v[104:107]
    v_mfma_f32_16x16x32_bf16 v[108:111], a[28:31], v[36:39], v[108:111]
    buffer_load_dwordx4 v[36:39], v124, s[40:43], s72 offen offset:1024 sc1
    ds_write_b128 v6, v[28:31] offset:35840
    s_cbranch_vccnz G_c10_r
G_c10:
    v_mfma_f32_16x16x32_bf16 v[96:99], a[32:35], v[40:43], v[96:99]
    v_mfma_f32_16x16x32_bf16 v[100:103], a[36:39], v[40:43], v[100:103]
    s_waitcnt vmcnt(8)
    v_cmp_eq_u32 vcc, -1, v47
    v_mfma_f32_16x16x32_bf16 v[104:107], a[40:43], v[40:43], v[104:107]
    v_mfma_f32_16x16x32_bf16 v[108:111], a[44:47], v[40:43], v[108:111]
    buffer_load_dwordx4 v[40:43], v124, s[40:43], s72 offen offset:2048 sc1
    s_waitcnt lgkmcnt(0)
    s_barrier
    s_cbranch_vccnz G_c11_r
G_c11:
    v_mfma_f32_16x16x32_bf16 v[96:99], a[48:51], v[44:47], v[96:99]
    ds_read_b64 v[16:17], v7 offset:32768
    ds_read_b64 v[18:19], v7 offset:36864
    v_mfma_f32_16x16x32_bf16 v[100:103], a[52:55], v[44:47], v[100:103]
    s_waitcnt vmcnt(7)
    v_cmp_eq_u32 vcc, -1, v51
    ds_read_b64 v[20:21], v7 offset:40960
    ds_read_b64 v[22:23], v7 offset:45056
    v_mfma_f32_16x16x32_bf16 v[104:107], a[56:59], v[44:47], v[104:107]
    ds_read_b64 v[24:25], v7 offset:49152
    ds_read_b64 v[26:27], v7 offset:53248
    v_mfma_f32_16x16x32_bf16 v[108:111], a[60:63], v[44:47], v[108:111]
    buffer_load_dwordx4 v[44:47], v124, s[40:43], s72 offen offset:3072 sc1
    ds_read_b64 v[28:29], v7 offset:57344
    ds_read_b64 v[30:31], v7 offset:61440
    s_cbranch_vccnz G_c12_r
G_c12:
    v_mfma_f32_16x16x32_bf16 v[96:99], a[64:67], v[48:51], v[96:99]
    s_waitcnt lgkmcnt(4)
    v_add_f32 v16, v16, v18
    v_add_f32 v17, v17, v19
    v_add_f32 v20, v20, v22
    v_add_f32 v21, v21, v23
    v_mfma_f32_16x16x32_bf16 v[100:103], a[68:71], v[48:51], v[100:103]
    s_waitcnt vmcnt(7)
    v_cmp_eq_u32 vcc, -1, v55
    s_waitcnt lgkmcnt(0)
    v_add_f32 v24, v24, v26
    v_add_f32 v25, v25, v27
    v_add_f32 v28, v28, v30
    v_add_f32 v29, v29, v31
    s_add_u32 m0, s86, 2048
    s_add_u32 s68, s85, 327680
    v_mfma_f32_16x16x32_bf16 v[104:107], a[72:75], v[48:51], v[104:107]
    v_add_f32 v16, v16, v20
    v_add_f32 v17, v17, v21
    v_add_f32 v24, v24, v28
    v_add_f32 v25, v25, v29
    buffer_load_dwordx4 v8, s[24:27], s68 offen offset:0 lds
    v_mfma_f32_16x16x32_bf16 v[108:111], a[76:79], v[48:51], v[108:111]
    buffer_load_dwordx4 v[48:51], v124, s[40:43], s73 offen offset:0 sc1
    v_add_f32 v126, v16, v24
    v_add_f32 v127, v17, v25
    v_add_f32 v126, v126, v112
    v_add_f32 v127, v127, v113
    s_cbranch_vccnz G_c13_r
G_c13:
    v_mfma_f32_16x16x32_bf16 v[96:99], a[80:83], v[52:55], v[96:99]
    v_mul_f32 v5, v126, v126
    v_mul_f32 v11, v127, v127
    v_fma_f32 v5, v5, s77, v115
    v_fma_f32 v11, v11, s77, v115
    v_mfma_f32_16x16x32_bf16 v[100:103], a[84:87], v[52:55], v[100:103]
    s_waitcnt vmcnt(8)
    v_cmp_eq_u32 vcc, -1, v59
    v_mul_f32 v5, v5, v126
    v_mul_f32 v11, v11, v127
    v_exp_f32 v5, v5
    v_exp_f32 v11, v11
    v_mfma_f32_16x16x32_bf16 v[104:107], a[88:91], v[52:55], v[104:107]
    v_add_f32 v5, 1.0, v5
    v_add_f32 v11, 1.0, v11
    v_rcp_f32 v5, v5
    v_rcp_f32 v11, v11
    v_mfma_f32_16x16x32_bf16 v[108:111], a[92:95], v[52:55], v[108:111]
    buffer_load_dwordx4 v[52:55], v124, s[40:43], s73 offen offset:1024 sc1
    v_mul_f32 v126, v126, v5
    v_mul_f32 v127, v127, v11
    v_cvt_pk_bf16_f32 v120, v126, v127
    s_nop 0
    s_cbranch_vccnz G_c14_r
G_c14:
    v_mfma_f32_16x16x32_bf16 v[96:99], a[96:99], v[56:59], v[96:99]
    v_mov_b32_dpp v121, v120 quad_perm:[1,1,1,1] row_mask:0xf bank_mask:0xf
    v_mov_b32_dpp v122, v120 quad_perm:[2,2,2,2] row_mask:0xf bank_mask:0xf
    v_mov_b32_dpp v123, v120 quad_perm:[3,3,3,3] row_mask:0xf bank_mask:0xf
    buffer_store_dwordx4 v[120:123], v3, s[40:43], s76 offen sc1
    v_mfma_f32_16x16x32_bf16 v[100:103], a[100:103], v[56:59], v[100:103]
    s_waitcnt vmcnt(9)
    v_cmp_eq_u32 vcc, -1, v63
    v_mfma_f32_16x16x32_bf16 v[104:107], a[104:107], v[56:59], v[104:107]
    v_mfma_f32_16x16x32_bf16 v[108:111], a[108:111], v[56:59], v[108:111]
    buffer_load_dwordx4 v[56:59], v124, s[40:43], s73 offen offset:2048 sc1
    s_cbranch_vccnz G_c15_r
G_c15:
    v_mfma_f32_16x16x32_bf16 v[96:99], a[112:115], v[60:63], v[96:99]
    v_mfma_f32_16x16x32_bf16 v[100:103], a[116:119], v[60:63], v[100:103]
    s_waitcnt vmcnt(8)
    v_cmp_eq_u32 vcc, -1, v35
    v_mfma_f32_16x16x32_bf16 v[104:107], a[120:123], v[60:63], v[104:107]
    v_mfma_f32_16x16x32_bf16 v[108:111], a[124:127], v[60:63], v[108:111]
    buffer_load_dwordx4 v[60:63], v124, s[40:43], s73 offen offset:3072 sc1
    s_cbranch_vccnz G_c16_r
G_c16:
    v_mfma_f32_16x16x32_bf16 v[16:19], a[0:3], v[32:35], 0
    buffer_load_dwordx4 v9, s[24:27], s68 offen offset:1024 lds
    v_mfma_f32_16x16x32_bf16 v[20:23], a[4:7], v[32:35], 0
    s_waitcnt vmcnt(9)
    v_cmp_eq_u32 vcc, -1, v39
    ds_write_b128 v6, v[96:99] offset:0
    v_mfma_f32_16x16x32_bf16 v[24:27], a[8:11], v[32:35], 0
    v_mfma_f32_16x16x32_bf16 v[28:31], a[12:15], v[32:35], 0
    v_add_u32 v125, 196608, v4
    buffer_load_dwordx4 v[32:35], v125, s[40:43], s72 offen offset:0 sc1
    ds_write_b128 v6, v[100:103] offset:1024
    s_cbranch_vccnz G_c17_r
G_c17:
    v_mfma_f32_16x16x32_bf16 v[16:19], a[16:19], v[36:39], v[16:19]
    v_mfma_f32_16x16x32_bf16 v[20:23], a[20:23], v[36:39], v[20:23]
    s_waitcnt vmcnt(9)
    v_cmp_eq_u32 vcc, -1, v43
    ds_write_b128 v6, v[104:107] offset:2048
    v_mfma_f32_16x16x32_bf16 v[24:27], a[24:27], v[36:39], v[24:27]
    v_mfma_f32_16x16x32_bf16 v[28:31], a[28:31], v[36:39], v[28:31]
    buffer_load_dwordx4 v[36:39], v125, s[40:43], s72 offen offset:1024 sc1
    ds_write_b128 v6, v[108:111] offset:3072
    s_cbranch_vccnz G_c18_r
G_c18:
    v_mfma_f32_16x16x32_bf16 v[16:19], a[32:35], v[40:43], v[16:19]
    v_mfma_f32_16x16x32_bf16 v[20:23], a[36:39], v[40:43], v[20:23]
    s_waitcnt vmcnt(9)
    v_cmp_eq_u32 vcc, -1, v47
    v_mfma_f32_16x16x32_bf16 v[24:27], a[40:43], v[40:43], v[24:27]
    v_mfma_f32_16x16x32_bf16 v[28:31], a[44:47], v[40:43], v[28:31]
    buffer_load_dwordx4 v[40:43], v125, s[40:43], s72 offen offset:2048 sc1
    s_waitcnt lgkmcnt(0)
    s_barrier
    s_cbranch_vccnz G_c19_r
G_c19:
    v_mfma_f32_16x16x32_bf16 v[16:19], a[48:51], v[44:47], v[16:19]
    ds_read_b64 v[96:97], v7 offset:0
    ds_read_b64 v[98:99], v7 offset:4096
    v_mfma_f32_16x16x32_bf16 v[20:23], a[52:55], v[44:47], v[20:23]
    s_waitcnt vmcnt(8)
    v_cmp_eq_u32 vcc, -1, v51
    ds_read_b64 v[100:101], v7 offset:8192
    ds_read_b64 v[102:103], v7 offset:12288
    v_mfma_f32_16x16x32_bf16 v[24:27], a[56:59], v[44:47], v[24:27]
    ds_read_b64 v[104:105], v7 offset:16384
    ds_read_b64 v[106:107], v7 offset:20480
    v_mfma_f32_16x16x32_bf16 v[28:31], a[60:63], v[44:47], v[28:31]
    buffer_load_dwordx4 v[44:47], v125, s[40:43], s72 offen offset:3072 sc1
    ds_read_b64 v[108:109], v7 offset:24576
    ds_read_b64 v[110:111], v7 offset:28672
    s_cbranch_vccnz G_c20_r
G_c20:
    v_mfma_f32_16x16x32_bf16 v[16:19], a[64:67], v[48:51], v[16:19]
    s_waitcnt lgkmcnt(4)
    v_add_f32 v96, v96, v98
    v_add_f32 v97, v97, v99
    v_add_f32 v100, v100, v102
    v_add_f32 v101, v101, v103
    v_mfma_f32_16x16x32_bf16 v[20:23], a[68:71], v[48:51], v[20:23]
    s_waitcnt vmcnt(8)
    v_cmp_eq_u32 vcc, -1, v55
    s_waitcnt lgkmcnt(0)
    v_add_f32 v104, v104, v106
    v_add_f32 v105, v105, v107
    v_add_f32 v108, v108, v110
    v_add_f32 v109, v109, v111
    v_mfma_f32_16x16x32_bf16 v[24:27], a[72:75], v[48:51], v[24:27]
    v_add_f32 v96, v96, v100
    v_add_f32 v97, v97, v101
    v_add_f32 v104, v104, v108
    v_add_f32 v105, v105, v109
    v_mfma_f32_16x16x32_bf16 v[28:31], a[76:79], v[48:51], v[28:31]
    buffer_load_dwordx4 v[48:51], v125, s[40:43], s73 offen offset:0 sc1
    v_add_f32 v126, v96, v104
    v_add_f32 v127, v97, v105
    v_add_f32 v126, v126, v112
    v_add_f32 v127, v127, v113
    s_cbranch_vccnz G_c21_r
G_c21:
    v_mfma_f32_16x16x32_bf16 v[16:19], a[80:83], v[52:55], v[16:19]
    v_mul_f32 v5, v126, v126
    v_mul_f32 v11, v127, v127
    v_fma_f32 v5, v5, s77, v115
    v_fma_f32 v11, v11, s77, v115
    v_mfma_f32_16x16x32_bf16 v[20:23], a[84:87], v[52:55], v[20:23]
    s_waitcnt vmcnt(7)
    v_cmp_eq_u32 vcc, -1, v59
    v_mul_f32 v5, v5, v126
    v_mul_f32 v11, v11, v127
    v_exp_f32 v5, v5
    v_exp_f32 v11, v11
    v_mfma_f32_16x16x32_bf16 v[24:27], a[88:91], v[52:55], v[24:27]
    v_add_f32 v5, 1.0, v5
    v_add_f32 v11, 1.0, v11
    v_rcp_f32 v5, v5
    v_rcp_f32 v11, v11
    v_mfma_f32_16x16x32_bf16 v[28:31], a[92:95], v[52:55], v[28:31]
    buffer_load_dwordx4 v[52:55], v125, s[40:43], s73 offen offset:1024 sc1
    v_mul_f32 v126, v126, v5
    v_mul_f32 v127, v127, v11
    v_cvt_pk_bf16_f32 v120, v126, v127
    s_add_u32 s76, s76, 57344
    s_cbranch_vccnz G_c22_r
G_c22:
    v_mfma_f32_16x16x32_bf16 v[16:19], a[96:99], v[56:59], v[16:19]
    v_mov_b32_dpp v121, v120 quad_perm:[1,1,1,1] row_mask:0xf bank_mask:0xf
    v_mov_b32_dpp v122, v120 quad_perm:[2,2,2,2] row_mask:0xf bank_mask:0xf
    v_mov_b32_dpp v123, v120 quad_perm:[3,3,3,3] row_mask:0xf bank_mask:0xf
    buffer_store_dwordx4 v[120:123], v3, s[40:43], s76 offen sc1
    v_mfma_f32_16x16x32_bf16 v[20:23], a[100:103], v[56:59], v[20:23]
    s_waitcnt vmcnt(8)
    v_cmp_eq_u32 vcc, -1, v63
    v_mfma_f32_16x16x32_bf16 v[24:27], a[104:107], v[56:59], v[24:27]
    v_mfma_f32_16x16x32_bf16 v[28:31], a[108:111], v[56:59], v[28:31]
    buffer_load_dwordx4 v[56:59], v125, s[40:43], s73 offen offset:2048 sc1
    s_cbranch_vccnz G_c23_r
G_c23:
    v_mfma_f32_16x16x32_bf16 v[16:19], a[112:115], v[60:63], v[16:19]
    v_mfma_f32_16x16x32_bf16 v[20:23], a[116:119], v[60:63], v[20:23]
    s_waitcnt vmcnt(7)
    v_cmp_eq_u32 vcc, -1, v35
    v_mfma_f32_16x16x32_bf16 v[24:27], a[120:123], v[60:63], v[24:27]
    v_mfma_f32_16x16x32_bf16 v[28:31], a[124:127], v[60:63], v[28:31]
    buffer_load_dwordx4 v[60:63], v125, s[40:43], s73 offen offset:3072 sc1
    s_cbranch_vccnz G_c24_r
G_c24:
    v_mfma_f32_16x16x32_bf16 v[96:99], a[0:3], v[32:35], 0
    v_mfma_f32_16x16x32_bf16 v[100:103], a[4:7], v[32:35], 0
    s_waitcnt vmcnt(7)
    v_cmp_eq_u32 vcc, -1, v39
    ds_write_b128 v6, v[16:19] offset:32768
    v_mfma_f32_16x16x32_bf16 v[104:107], a[8:11], v[32:35], 0
    v_mfma_f32_16x16x32_bf16 v[108:111], a[12:15], v[32:35], 0
    v_add_u32 v124, 0, v4
    buffer_load_dwordx4 v[32:35], v124, s[40:43], s74 offen offset:0 sc1
    ds_write_b128 v6, v[20:23] offset:33792
    s_cbranch_vccnz G_c25_r
G_c25:
    v_mfma_f32_16x16x32_bf16 v[96:99], a[16:19], v[36:39], v[96:99]
    ds_read_b64_tr_b16 a[0:1], v12 offset:0
    ds_read_b64_tr_b16 a[2:3], v12 offset:512
    v_mfma_f32_16x16x32_bf16 v[100:103], a[20:23], v[36:39], v[100:103]
    s_waitcnt vmcnt(7)
    v_cmp_eq_u32 vcc, -1, v43
    ds_write_b128 v6, v[24:27] offset:34816
    ds_read_b64_tr_b16 a[4:5], v13 offset:0
    ds_read_b64_tr_b16 a[6:7], v13 offset:512
    v_mfma_f32_16x16x32_bf16 v[104:107], a[24:27], v[36:39], v[104:107]
    ds_read_b64_tr_b16 a[8:9], v14 offset:0
    ds_read_b64_tr_b16 a[10:11], v14 offset:512
    v_mfma_f32_16x16x32_bf16 v[108:111], a[28:31], v[36:39], v[108:111]
    buffer_load_dwordx4 v[36:39], v124, s[40:43], s74 offen offset:1024 sc1
    ds_write_b128 v6, v[28:31] offset:35840
    ds_read_b64_tr_b16 a[12:13], v15 offset:0
    ds_read_b64_tr_b16 a[14:15], v15 offset:512
    s_cbranch_vccnz G_c26_r
G_c26:
    v_mfma_f32_16x16x32_bf16 v[96:99], a[32:35], v[40:43], v[96:99]
    ds_read_b64_tr_b16 a[16:17], v12 offset:32768
    ds_read_b64_tr_b16 a[18:19], v12 offset:33280
    s_waitcnt lgkmcnt(2)
    v_mfma_f32_16x16x32_bf16 v[100:103], a[36:39], v[40:43], v[100:103]
    s_waitcnt vmcnt(7)
    v_cmp_eq_u32 vcc, -1, v47
    ds_read_b64_tr_b16 a[20:21], v13 offset:32768
    ds_read_b64_tr_b16 a[22:23], v13 offset:33280
    s_add_u32 m0, s86, 0
    s_add_u32 s68, s85, 655360
    v_mfma_f32_16x16x32_bf16 v[104:107], a[40:43], v[40:43], v[104:107]
    ds_read_b64_tr_b16 a[24:25], v14 offset:32768
    ds_read_b64_tr_b16 a[26:27], v14 offset:33280
    buffer_load_dwordx4 v8, s[24:27], s68 offen offset:0 lds
    v_mfma_f32_16x16x32_bf16 v[108:111], a[44:47], v[40:43], v[108:111]
    buffer_load_dwordx4 v[40:43], v124, s[40:43], s74 offen offset:2048 sc1
    ds_read_b64_tr_b16 a[28:29], v15 offset:32768
    ds_read_b64_tr_b16 a[30:31], v15 offset:33280
    s_barrier
    s_cbranch_vccnz G_c27_r
G_c27:
    v_mfma_f32_16x16x32_bf16 v[96:99], a[48:51], v[44:47], v[96:99]
    ds_read_b64 v[16:17], v7 offset:32768
    ds_read_b64 v[18:19], v7 offset:36864
    buffer_load_dwordx4 v9, s[24:27], s68 offen offset:1024 lds
    v_mfma_f32_16x16x32_bf16 v[100:103], a[52:55], v[44:47], v[100:103]
    s_waitcnt vmcnt(9)
    v_cmp_eq_u32 vcc, -1, v51
    ds_read_b64 v[20:21], v7 offset:40960
    ds_read_b64 v[22:23], v7 offset:45056
    v_mfma_f32_16x16x32_bf16 v[104:107], a[56:59], v[44:47], v[104:107]
    ds_read_b64 v[24:25], v7 offset:49152
    ds_read_b64 v[26:27], v7 offset:53248
    v_mfma_f32_16x16x32_bf16 v[108:111], a[60:63], v[44:47], v[108:111]
    buffer_load_dwordx4 v[44:47], v124, s[40:43], s74 offen offset:3072 sc1
    ds_read_b64 v[28:29], v7 offset:57344
    ds_read_b64 v[30:31], v7 offset:61440
    s_cbranch_vccnz G_c28_r
G_c28:
    v_mfma_f32_16x16x32_bf16 v[96:99], a[64:67], v[48:51], v[96:99]
    s_waitcnt lgkmcnt(4)
    v_add_f32 v16, v16, v18
    v_add_f32 v17, v17, v19
    v_add_f32 v20, v20, v22
    v_add_f32 v21, v21, v23
    v_mfma_f32_16x16x32_bf16 v[100:103], a[68:71], v[48:51], v[100:103]
    s_waitcnt vmcnt(9)
    v_cmp_eq_u32 vcc, -1, v55
    s_waitcnt lgkmcnt(0)
    v_add_f32 v24, v24, v26
    v_add_f32 v25, v25, v27
    v_add_f32 v28, v28, v30
    v_add_f32 v29, v29, v31
    s_add_u32 m0, s86, 2048
    s_add_u32 s68, s85, 720896
    v_mfma_f32_16x16x32_bf16 v[104:107], a[72:75], v[48:51], v[104:107]
    v_add_f32 v16, v16, v20
    v_add_f32 v17, v17, v21
    v_add_f32 v24, v24, v28
    v_add_f32 v25, v25, v29
    buffer_load_dwordx4 v8, s[24:27], s68 offen offset:0 lds
    v_mfma_f32_16x16x32_bf16 v[108:111], a[76:79], v[48:51], v[108:111]
    buffer_load_dwordx4 v[48:51], v124, s[40:43], s75 offen offset:0 sc1
    v_add_f32 v126, v16, v24
    v_add_f32 v127, v17, v25
    v_add_f32 v126, v126, v112
    v_add_f32 v127, v127, v113
    s_cbranch_vccnz G_c29_r
G_c29:
    v_mfma_f32_16x16x32_bf16 v[96:99], a[80:83], v[52:55], v[96:99]
    v_mul_f32 v5, v126, v126
    v_mul_f32 v11, v127, v127
    v_fma_f32 v5, v5, s77, v115
    v_fma_f32 v11, v11, s77, v115
    buffer_load_dwordx4 v9, s[24:27], s68 offen offset:1024 lds
    v_mfma_f32_16x16x32_bf16 v[100:103], a[84:87], v[52:55], v[100:103]
    s_waitcnt vmcnt(10)
    v_cmp_eq_u32 vcc, -1, v59
    v_mul_f32 v5, v5, v126
    v_mul_f32 v11, v11, v127
    v_exp_f32 v5, v5
    v_exp_f32 v11, v11
    s_add_u32 m0, s86, 32768
    s_add_u32 s68, s85, 786432
    v_mfma_f32_16x16x32_bf16 v[104:107], a[88:91], v[52:55], v[104:107]
    v_add_f32 v5, 1.0, v5
    v_add_f32 v11, 1.0, v11
    v_rcp_f32 v5, v5
    v_rcp_f32 v11, v11
    buffer_load_dwordx4 v8, s[24:27], s68 offen offset:0 lds
    v_mfma_f32_16x16x32_bf16 v[108:111], a[92:95], v[52:55], v[108:111]
    buffer_load_dwordx4 v[52:55], v124, s[40:43], s75 offen offset:1024 sc1
    v_mul_f32 v126, v126, v5
    v_mul_f32 v127, v127, v11
    v_cvt_pk_bf16_f32 v120, v126, v127
    s_add_u32 s76, s76, 57344
    v_xor_b32 v12, 0x10000, v12
    v_xor_b32 v13, 0x10000, v13
    v_xor_b32 v14, 0x10000, v14
    v_xor_b32 v15, 0x10000, v15
    s_cbranch_vccnz G_c30_r
G_c30:
    v_mfma_f32_16x16x32_bf16 v[96:99], a[96:99], v[56:59], v[96:99]
    v_mov_b32_dpp v121, v120 quad_perm:[1,1,1,1] row_mask:0xf bank_mask:0xf
    v_mov_b32_dpp v122, v120 quad_perm:[2,2,2,2] row_mask:0xf bank_mask:0xf
    v_mov_b32_dpp v123, v120 quad_perm:[3,3,3,3] row_mask:0xf bank_mask:0xf
    buffer_store_dwordx4 v[120:123], v3, s[40:43], s76 offen sc1
    ds_read_b64_tr_b16 a[32:33], v12 offset:0
    ds_read_b64_tr_b16 a[34:35], v12 offset:512
    buffer_load_dwordx4 v9, s[24:27], s68 offen offset:1024 lds
    v_mfma_f32_16x16x32_bf16 v[100:103], a[100:103], v[56:59], v[100:103]
    s_waitcnt vmcnt(13)
    v_cmp_eq_u32 vcc, -1, v63
    ds_read_b64_tr_b16 a[36:37], v13 offset:0
    ds_read_b64_tr_b16 a[38:39], v13 offset:512
    s_add_u32 m0, s86, 34816
    s_add_u32 s68, s85, 851968
    v_mfma_f32_16x16x32_bf16 v[104:107], a[104:107], v[56:59], v[104:107]
    ds_read_b64_tr_b16 a[40:41], v14 offset:0
    ds_read_b64_tr_b16 a[42:43], v14 offset:512
    buffer_load_dwordx4 v8, s[24:27], s68 offen offset:0 lds
    v_mfma_f32_16x16x32_bf16 v[108:111], a[108:111], v[56:59], v[108:111]
    buffer_load_dwordx4 v[56:59], v124, s[40:43], s75 offen offset:2048 sc1
    ds_read_b64_tr_b16 a[44:45], v15 offset:0
    ds_read_b64_tr_b16 a[46:47], v15 offset:512
    s_cbranch_vccnz G_c31_r
G_c31:
    v_mfma_f32_16x16x32_bf16 v[96:99], a[112:115], v[60:63], v[96:99]
    v_xor_b32 v12, 0x10000, v12
    v_xor_b32 v13, 0x10000, v13
    v_xor_b32 v14, 0x10000, v14
    v_xor_b32 v15, 0x10000, v15
    buffer_load_dwordx4 v9, s[24:27], s68 offen offset:1024 lds
    v_mfma_f32_16x16x32_bf16 v[100:103], a[116:119], v[60:63], v[100:103]
    s_waitcnt vmcnt(15)
    v_cmp_eq_u32 vcc, -1, v35
    v_mfma_f32_16x16x32_bf16 v[104:107], a[120:123], v[60:63], v[104:107]
    v_mfma_f32_16x16x32_bf16 v[108:111], a[124:127], v[60:63], v[108:111]
    v_add_u32 v125, 57344, v4
    buffer_load_dwordx4 v[60:63], v125, s[40:43], s74 offen offset:0 sc1
P5_entry:
    s_cbranch_vccnz G_c32_r
G_c32:
    v_mfma_f32_16x16x32_bf16 v[16:19], v[32:35], v[64:67], 0
    v_mfma_f32_16x16x32_bf16 v[20:23], v[32:35], v[68:71], 0
    s_waitcnt vmcnt(15)
    v_cmp_eq_u32 vcc, -1, v39
    ds_write_b128 v6, v[96:99] offset:0
    v_mfma_f32_16x16x32_bf16 v[24:27], v[32:35], v[72:75], 0
    v_mfma_f32_16x16x32_bf16 v[28:31], v[32:35], v[76:79], 0
    buffer_load_dwordx4 v[32:35], v125, s[40:43], s74 offen offset:1024 sc1
    ds_write_b128 v6, v[100:103] offset:1024
    s_cbranch_vccnz G_c33_r
G_c33:
    v_mfma_f32_16x16x32_bf16 v[16:19], v[36:39], v[80:83], v[16:19]
    v_mfma_f32_16x16x32_bf16 v[20:23], v[36:39], v[84:87], v[20:23]
    s_waitcnt vmcnt(14)
    v_cmp_eq_u32 vcc, -1, v43
    ds_write_b128 v6, v[104:107] offset:2048
    v_mfma_f32_16x16x32_bf16 v[24:27], v[36:39], v[88:91], v[24:27]
    v_mfma_f32_16x16x32_bf16 v[28:31], v[36:39], v[92:95], v[28:31]
    buffer_load_dwordx4 v[36:39], v125, s[40:43], s74 offen offset:2048 sc1
    ds_write_b128 v6, v[108:111] offset:3072
    s_cbranch_vccnz G_c34_r
G_c34:
    v_mfma_f32_16x16x32_bf16 v[16:19], v[40:43], a[0:3], v[16:19]
    v_mfma_f32_16x16x32_bf16 v[20:23], v[40:43], a[4:7], v[20:23]
    s_waitcnt vmcnt(13)
    v_cmp_eq_u32 vcc, -1, v47
    v_mfma_f32_16x16x32_bf16 v[24:27], v[40:43], a[8:11], v[24:27]
    v_mfma_f32_16x16x32_bf16 v[28:31], v[40:43], a[12:15], v[28:31]
    buffer_load_dwordx4 v[40:43], v125, s[40:43], s74 offen offset:3072 sc1
    s_waitcnt lgkmcnt(0)
    s_barrier
    s_cbranch_vccnz G_c35_r
G_c35:
    v_mfma_f32_16x16x32_bf16 v[16:19], v[44:47], a[16:19], v[16:19]
    ds_read_b64 v[96:97], v7 offset:0
    ds_read_b64 v[98:99], v7 offset:4096
    v_mfma_f32_16x16x32_bf16 v[20:23], v[44:47], a[20:23], v[20:23]
    s_waitcnt vmcnt(12)
    v_cmp_eq_u32 vcc, -1, v51
    ds_read_b64 v[100:101], v7 offset:8192
    ds_read_b64 v[102:103], v7 offset:12288
    v_mfma_f32_16x16x32_bf16 v[24:27], v[44:47], a[24:27], v[24:27]
    ds_read_b64 v[104:105], v7 offset:16384
    ds_read_b64 v[106:107], v7 offset:20480
    v_mfma_f32_16x16x32_bf16 v[28:31], v[44:47], a[28:31], v[28:31]
    buffer_load_dwordx4 v[44:47], v125, s[40:43], s75 offen offset:0 sc1
    ds_read_b64 v[108:109], v7 offset:24576
    ds_read_b64 v[110:111], v7 offset:28672
    s_waitcnt vmcnt(12)
    s_cbranch_vccnz G_c36_r
G_c36:
    v_mfma_f32_16x16x32_bf16 v[16:19], v[48:51], a[32:35], v[16:19]
    s_waitcnt lgkmcnt(4)
    v_add_f32 v96, v96, v98
    v_add_f32 v97, v97, v99
    v_add_f32 v100, v100, v102
    v_add_f32 v101, v101, v103
    ds_read_b64_tr_b16 a[48:49], v12 offset:0
    ds_read_b64_tr_b16 a[50:51], v12 offset:512
    v_mfma_f32_16x16x32_bf16 v[20:23], v[48:51], a[36:39], v[20:23]
    s_waitcnt vmcnt(10)
    v_cmp_eq_u32 vcc, -1, v55
    s_waitcnt lgkmcnt(2)
    v_add_f32 v104, v104, v106
    v_add_f32 v105, v105, v107
    v_add_f32 v108, v108, v110
    v_add_f32 v109, v109, v111
    ds_read_b64_tr_b16 a[52:53], v13 offset:0
    ds_read_b64_tr_b16 a[54:55], v13 offset:512
    v_mfma_f32_16x16x32_bf16 v[24:27], v[48:51], a[40:43], v[24:27]
    v_add_f32 v96, v96, v100
    v_add_f32 v97, v97, v101
    v_add_f32 v104, v104, v108
    v_add_f32 v105, v105, v109
    ds_read_b64_tr_b16 a[56:57], v14 offset:0
    ds_read_b64_tr_b16 a[58:59], v14 offset:512
    v_mfma_f32_16x16x32_bf16 v[28:31], v[48:51], a[44:47], v[28:31]
    buffer_load_dwordx4 v[48:51], v125, s[40:43], s75 offen offset:1024 sc1
    v_add_f32 v126, v96, v104
    v_add_f32 v127, v97, v105
    v_add_f32 v126, v126, v112
    v_add_f32 v127, v127, v113
    ds_read_b64_tr_b16 a[60:61], v15 offset:0
    ds_read_b64_tr_b16 a[62:63], v15 offset:512
    s_waitcnt vmcnt(6)
    s_waitcnt lgkmcnt(0)
    s_cbranch_vccnz G_c37_r
G_c37:
    v_mfma_f32_16x16x32_bf16 v[16:19], v[52:55], a[48:51], v[16:19]
    v_mul_f32 v5, v126, v126
    v_mul_f32 v11, v127, v127
    v_fma_f32 v5, v5, s77, v115
    v_fma_f32 v11, v11, s77, v115
    ds_read_b64_tr_b16 a[64:65], v12 offset:32768
    ds_read_b64_tr_b16 a[66:67], v12 offset:33280
    v_mfma_f32_16x16x32_bf16 v[20:23], v[52:55], a[52:55], v[20:23]
    v_cmp_eq_u32 vcc, -1, v59
    v_mul_f32 v5, v5, v126
    v_mul_f32 v11, v11, v127
    v_exp_f32 v5, v5
    v_exp_f32 v11, v11
    ds_read_b64_tr_b16 a[68:69], v13 offset:32768
    ds_read_b64_tr_b16 a[70:71], v13 offset:33280
    v_mfma_f32_16x16x32_bf16 v[24:27], v[52:55], a[56:59], v[24:27]
    v_add_f32 v5, 1.0, v5
    v_add_f32 v11, 1.0, v11
    v_rcp_f32 v5, v5
    v_rcp_f32 v11, v11
    ds_read_b64_tr_b16 a[72:73], v14 offset:32768
    ds_read_b64_tr_b16 a[74:75], v14 offset:33280
    v_mfma_f32_16x16x32_bf16 v[28:31], v[52:55], a[60:63], v[28:31]
    buffer_load_dwordx4 v[52:55], v125, s[40:43], s75 offen offset:2048 sc1
    v_mul_f32 v126, v126, v5
    v_mul_f32 v127, v127, v11
    v_cvt_pk_bf16_f32 v120, v126, v127
    s_add_u32 s76, s76, 57344
    ds_read_b64_tr_b16 a[76:77], v15 offset:32768
    ds_read_b64_tr_b16 a[78:79], v15 offset:33280
    s_waitcnt lgkmcnt(0)
    s_cbranch_vccnz G_c38_r
G_c38:
    v_mfma_f32_16x16x32_bf16 v[16:19], v[56:59], a[64:67], v[16:19]
    v_mov_b32_dpp v121, v120 quad_perm:[1,1,1,1] row_mask:0xf bank_mask:0xf
    v_mov_b32_dpp v122, v120 quad_perm:[2,2,2,2] row_mask:0xf bank_mask:0xf
    v_mov_b32_dpp v123, v120 quad_perm:[3,3,3,3] row_mask:0xf bank_mask:0xf
    buffer_store_dwordx4 v[120:123], v3, s[40:43], s76 offen sc1
    v_mfma_f32_16x16x32_bf16 v[20:23], v[56:59], a[68:71], v[20:23]
    s_waitcnt vmcnt(7)
    v_cmp_eq_u32 vcc, -1, v63
    v_mfma_f32_16x16x32_bf16 v[24:27], v[56:59], a[72:75], v[24:27]
    v_mfma_f32_16x16x32_bf16 v[28:31], v[56:59], a[76:79], v[28:31]
    v_add_u32 v124, 114688, v4
    buffer_load_dwordx4 v[56:59], v124, s[40:43], s74 offen offset:0 sc1
    s_cbranch_vccnz G_c39_r
G_c39:
    v_mfma_f32_16x16x32_bf16 v[96:99], v[60:63], v[64:67], 0
    v_mfma_f32_16x16x32_bf16 v[100:103], v[60:63], v[68:71], 0
    s_waitcnt vmcnt(7)
    v_cmp_eq_u32 vcc, -1, v35
    ds_write_b128 v6, v[16:19] offset:32768
    v_mfma_f32_16x16x32_bf16 v[104:107], v[60:63], v[72:75], 0
    v_mfma_f32_16x16x32_bf16 v[108:111], v[60:63], v[76:79], 0
    buffer_load_dwordx4 v[60:63], v124, s[40:43], s74 offen offset:1024 sc1
    ds_write_b128 v6, v[20:23] offset:33792
    s_cbranch_vccnz G_c40_r
G_c40:
    v_mfma_f32_16x16x32_bf16 v[96:99], v[32:35], v[80:83], v[96:99]
    v_mfma_f32_16x16x32_bf16 v[100:103], v[32:35], v[84:87], v[100:103]
    s_waitcnt vmcnt(7)
    v_cmp_eq_u32 vcc, -1, v39
    ds_write_b128 v6, v[24:27] offset:34816
    v_mfma_f32_16x16x32_bf16 v[104:107], v[32:35], v[88:91], v[104:107]
    v_mfma_f32_16x16x32_bf16 v[108:111], v[32:35], v[92:95], v[108:111]
    buffer_load_dwordx4 v[32:35], v124, s[40:43], s74 offen offset:2048 sc1
    ds_write_b128 v6, v[28:31] offset:35840
    s_cbranch_vccnz G_c41_r
G_c41:
    v_mfma_f32_16x16x32_bf16 v[96:99], v[36:39], a[0:3], v[96:99]
    v_lshlrev_b32 v5, 16, v116
    v_mfma_f32_16x16x32_bf16 v[100:103], v[36:39], a[4:7], v[100:103]
    s_waitcnt vmcnt(7)
    v_cmp_eq_u32 vcc, -1, v43
    v_and_b32 v11, 0xffff0000, v116
    v_mfma_f32_16x16x32_bf16 v[104:107], v[36:39], a[8:11], v[104:107]
    v_add_f32 v5, v5, v114
    v_mfma_f32_16x16x32_bf16 v[108:111], v[36:39], a[12:15], v[108:111]
    buffer_load_dwordx4 v[36:39], v124, s[40:43], s74 offen offset:3072 sc1
    v_add_f32 v11, v11, v114
    s_waitcnt lgkmcnt(0)
    s_barrier
    s_cbranch_vccnz G_c42_r
G_c42:
    v_mfma_f32_16x16x32_bf16 v[96:99], v[40:43], a[16:19], v[96:99]
    ds_read_b64 v[16:17], v7 offset:32768
    ds_read_b64 v[18:19], v7 offset:36864
    v_mfma_f32_16x16x32_bf16 v[100:103], v[40:43], a[20:23], v[100:103]
    s_waitcnt vmcnt(7)
    v_cmp_eq_u32 vcc, -1, v47
    ds_read_b64 v[20:21], v7 offset:40960
    ds_read_b64 v[22:23], v7 offset:45056
    v_mfma_f32_16x16x32_bf16 v[104:107], v[40:43], a[24:27], v[104:107]
    ds_read_b64 v[24:25], v7 offset:49152
    ds_read_b64 v[26:27], v7 offset:53248
    v_mfma_f32_16x16x32_bf16 v[108:111], v[40:43], a[28:31], v[108:111]
    buffer_load_dwordx4 v[40:43], v124, s[40:43], s75 offen offset:0 sc1
    ds_read_b64 v[28:29], v7 offset:57344
    ds_read_b64 v[30:31], v7 offset:61440
    s_cbranch_vccnz G_c43_r
G_c43:
    v_mfma_f32_16x16x32_bf16 v[96:99], v[44:47], a[32:35], v[96:99]
    s_waitcnt lgkmcnt(4)
    v_add_f32 v16, v16, v18
    v_add_f32 v17, v17, v19
    v_add_f32 v20, v20, v22
    v_add_f32 v21, v21, v23
    v_mfma_f32_16x16x32_bf16 v[100:103], v[44:47], a[36:39], v[100:103]
    s_waitcnt vmcnt(7)
    v_cmp_eq_u32 vcc, -1, v51
    s_waitcnt lgkmcnt(0)
    v_add_f32 v24, v24, v26
    v_add_f32 v25, v25, v27
    v_add_f32 v28, v28, v30
    v_add_f32 v29, v29, v31
    v_mfma_f32_16x16x32_bf16 v[104:107], v[44:47], a[40:43], v[104:107]
    v_add_f32 v16, v16, v20
    v_add_f32 v17, v17, v21
    v_add_f32 v24, v24, v28
    v_add_f32 v25, v25, v29
    v_mfma_f32_16x16x32_bf16 v[108:111], v[44:47], a[44:47], v[108:111]
    buffer_load_dwordx4 v[44:47], v124, s[40:43], s75 offen offset:1024 sc1
    v_add_f32 v126, v16, v24
    v_add_f32 v127, v17, v25
    v_add_f32 v126, v126, v5
    v_add_f32 v127, v127, v11
    s_cbranch_vccnz G_c44_r
G_c44:
    v_mfma_f32_16x16x32_bf16 v[96:99], v[48:51], a[48:51], v[96:99]
    v_cvt_pk_bf16_f32 v116, v126, v127
    buffer_store_dword v116, v10, s[32:35], 0 offen offset:0
    v_mfma_f32_16x16x32_bf16 v[100:103], v[48:51], a[52:55], v[100:103]
    s_waitcnt vmcnt(8)
    v_cmp_eq_u32 vcc, -1, v55
    v_mfma_f32_16x16x32_bf16 v[104:107], v[48:51], a[56:59], v[104:107]
    v_mfma_f32_16x16x32_bf16 v[108:111], v[48:51], a[60:63], v[108:111]
    buffer_load_dwordx4 v[48:51], v124, s[40:43], s75 offen offset:2048 sc1
    s_cbranch_vccnz G_c45_r
G_c45:
    v_mfma_f32_16x16x32_bf16 v[96:99], v[52:55], a[64:67], v[96:99]
    v_mfma_f32_16x16x32_bf16 v[100:103], v[52:55], a[68:71], v[100:103]
    s_waitcnt vmcnt(7)
    v_cmp_eq_u32 vcc, -1, v59
    v_mfma_f32_16x16x32_bf16 v[104:107], v[52:55], a[72:75], v[104:107]
    v_mfma_f32_16x16x32_bf16 v[108:111], v[52:55], a[76:79], v[108:111]
    v_add_u32 v125, 172032, v4
    buffer_load_dwordx4 v[52:55], v125, s[40:43], s74 offen offset:0 sc1
    s_cbranch_vccnz G_c46_r
G_c46:
    v_mfma_f32_16x16x32_bf16 v[16:19], v[56:59], v[64:67], 0
    v_mfma_f32_16x16x32_bf16 v[20:23], v[56:59], v[68:71], 0
    s_waitcnt vmcnt(7)
    v_cmp_eq_u32 vcc, -1, v63
    ds_write_b128 v6, v[96:99] offset:0
    v_mfma_f32_16x16x32_bf16 v[24:27], v[56:59], v[72:75], 0
    v_mfma_f32_16x16x32_bf16 v[28:31], v[56:59], v[76:79], 0
    buffer_load_dwordx4 v[56:59], v125, s[40:43], s74 offen offset:1024 sc1
    ds_write_b128 v6, v[100:103] offset:1024
    s_cbranch_vccnz G_c47_r
G_c47:
    v_mfma_f32_16x16x32_bf16 v[16:19], v[60:63], v[80:83], v[16:19]
    v_mfma_f32_16x16x32_bf16 v[20:23], v[60:63], v[84:87], v[20:23]
    s_waitcnt vmcnt(7)
    v_cmp_eq_u32 vcc, -1, v35
    ds_write_b128 v6, v[104:107] offset:2048
    v_mfma_f32_16x16x32_bf16 v[24:27], v[60:63], v[88:91], v[24:27]
    v_mfma_f32_16x16x32_bf16 v[28:31], v[60:63], v[92:95], v[28:31]
    buffer_load_dwordx4 v[60:63], v125, s[40:43], s74 offen offset:2048 sc1
    ds_write_b128 v6, v[108:111] offset:3072
    s_cbranch_vccnz G_c48_r
G_c48:
    v_mfma_f32_16x16x32_bf16 v[16:19], v[32:35], a[0:3], v[16:19]
    v_lshlrev_b32 v5, 16, v117
    v_mfma_f32_16x16x32_bf16 v[20:23], v[32:35], a[4:7], v[20:23]
    s_waitcnt vmcnt(7)
    v_cmp_eq_u32 vcc, -1, v39
    v_and_b32 v11, 0xffff0000, v117
    v_mfma_f32_16x16x32_bf16 v[24:27], v[32:35], a[8:11], v[24:27]
    v_add_f32 v5, v5, v114
    v_mfma_f32_16x16x32_bf16 v[28:31], v[32:35], a[12:15], v[28:31]
    buffer_load_dwordx4 v[32:35], v125, s[40:43], s74 offen offset:3072 sc1
    v_add_f32 v11, v11, v114
    s_waitcnt lgkmcnt(0)
    s_barrier
    s_cbranch_vccnz G_c49_r
G_c49:
    v_mfma_f32_16x16x32_bf16 v[16:19], v[36:39], a[16:19], v[16:19]
    ds_read_b64 v[96:97], v7 offset:0
    ds_read_b64 v[98:99], v7 offset:4096
    v_mfma_f32_16x16x32_bf16 v[20:23], v[36:39], a[20:23], v[20:23]
    s_waitcnt vmcnt(7)
    v_cmp_eq_u32 vcc, -1, v43
    ds_read_b64 v[100:101], v7 offset:8192
    ds_read_b64 v[102:103], v7 offset:12288
    v_mfma_f32_16x16x32_bf16 v[24:27], v[36:39], a[24:27], v[24:27]
    ds_read_b64 v[104:105], v7 offset:16384
    ds_read_b64 v[106:107], v7 offset:20480
    v_mfma_f32_16x16x32_bf16 v[28:31], v[36:39], a[28:31], v[28:31]
    buffer_load_dwordx4 v[36:39], v125, s[40:43], s75 offen offset:0 sc1
    ds_read_b64 v[108:109], v7 offset:24576
    ds_read_b64 v[110:111], v7 offset:28672
    s_cbranch_vccnz G_c50_r
G_c50:
    v_mfma_f32_16x16x32_bf16 v[16:19], v[40:43], a[32:35], v[16:19]
    s_waitcnt lgkmcnt(4)
    v_add_f32 v96, v96, v98
    v_add_f32 v97, v97, v99
    v_add_f32 v100, v100, v102
    v_add_f32 v101, v101, v103
    v_mfma_f32_16x16x32_bf16 v[20:23], v[40:43], a[36:39], v[20:23]
    s_waitcnt vmcnt(7)
    v_cmp_eq_u32 vcc, -1, v47
    s_waitcnt lgkmcnt(0)
    v_add_f32 v104, v104, v106
    v_add_f32 v105, v105, v107
    v_add_f32 v108, v108, v110
    v_add_f32 v109, v109, v111
    v_mfma_f32_16x16x32_bf16 v[24:27], v[40:43], a[40:43], v[24:27]
    v_add_f32 v96, v96, v100
    v_add_f32 v97, v97, v101
    v_add_f32 v104, v104, v108
    v_add_f32 v105, v105, v109
    v_mfma_f32_16x16x32_bf16 v[28:31], v[40:43], a[44:47], v[28:31]
    buffer_load_dwordx4 v[40:43], v125, s[40:43], s75 offen offset:1024 sc1
    v_add_f32 v126, v96, v104
    v_add_f32 v127, v97, v105
    v_add_f32 v126, v126, v5
    v_add_f32 v127, v127, v11
    s_cbranch_vccnz G_c51_r
G_c51:
    v_mfma_f32_16x16x32_bf16 v[16:19], v[44:47], a[48:51], v[16:19]
    v_cvt_pk_bf16_f32 v117, v126, v127
    buffer_store_dword v117, v10, s[32:35], 0 offen offset:32
    v_mfma_f32_16x16x32_bf16 v[20:23], v[44:47], a[52:55], v[20:23]
    s_waitcnt vmcnt(7)
    v_cmp_eq_u32 vcc, -1, v51
    v_mfma_f32_16x16x32_bf16 v[24:27], v[44:47], a[56:59], v[24:27]
    v_mfma_f32_16x16x32_bf16 v[28:31], v[44:47], a[60:63], v[28:31]
    buffer_load_dwordx4 v[44:47], v125, s[40:43], s75 offen offset:2048 sc1
    s_cbranch_vccnz G_c52_r
G_c52:
    v_mfma_f32_16x16x32_bf16 v[16:19], v[48:51], a[64:67], v[16:19]
    v_mfma_f32_16x16x32_bf16 v[20:23], v[48:51], a[68:71], v[20:23]
    s_waitcnt vmcnt(7)
    v_cmp_eq_u32 vcc, -1, v55
    v_mfma_f32_16x16x32_bf16 v[24:27], v[48:51], a[72:75], v[24:27]
    v_mfma_f32_16x16x32_bf16 v[28:31], v[48:51], a[76:79], v[28:31]
    s_cbranch_vccnz G_c53_r
G_c53:
    v_mfma_f32_16x16x32_bf16 v[96:99], v[52:55], v[64:67], 0
    v_mfma_f32_16x16x32_bf16 v[100:103], v[52:55], v[68:71], 0
    s_waitcnt vmcnt(6)
    v_cmp_eq_u32 vcc, -1, v59
    ds_write_b128 v6, v[16:19] offset:32768
    v_mfma_f32_16x16x32_bf16 v[104:107], v[52:55], v[72:75], 0
    v_mfma_f32_16x16x32_bf16 v[108:111], v[52:55], v[76:79], 0
    ds_write_b128 v6, v[20:23] offset:33792
    s_cbranch_vccnz G_c54_r
G_c54:
    v_mfma_f32_16x16x32_bf16 v[96:99], v[56:59], v[80:83], v[96:99]
    v_mfma_f32_16x16x32_bf16 v[100:103], v[56:59], v[84:87], v[100:103]
    s_waitcnt vmcnt(5)
    v_cmp_eq_u32 vcc, -1, v63
    ds_write_b128 v6, v[24:27] offset:34816
    v_mfma_f32_16x16x32_bf16 v[104:107], v[56:59], v[88:91], v[104:107]
    v_mfma_f32_16x16x32_bf16 v[108:111], v[56:59], v[92:95], v[108:111]
    ds_write_b128 v6, v[28:31] offset:35840
    s_cbranch_vccnz G_c55_r
G_c55:
    v_mfma_f32_16x16x32_bf16 v[96:99], v[60:63], a[0:3], v[96:99]
    v_lshlrev_b32 v5, 16, v118
    v_mfma_f32_16x16x32_bf16 v[100:103], v[60:63], a[4:7], v[100:103]
    s_waitcnt vmcnt(4)
    v_cmp_eq_u32 vcc, -1, v35
    v_and_b32 v11, 0xffff0000, v118
    v_mfma_f32_16x16x32_bf16 v[104:107], v[60:63], a[8:11], v[104:107]
    v_add_f32 v5, v5, v114
    v_mfma_f32_16x16x32_bf16 v[108:111], v[60:63], a[12:15], v[108:111]
    v_add_f32 v11, v11, v114
    s_waitcnt lgkmcnt(0)
    s_barrier
    s_cbranch_vccnz G_c56_r
G_c56:
    v_mfma_f32_16x16x32_bf16 v[96:99], v[32:35], a[16:19], v[96:99]
    ds_read_b64 v[16:17], v7 offset:32768
    ds_read_b64 v[18:19], v7 offset:36864
    v_mfma_f32_16x16x32_bf16 v[100:103], v[32:35], a[20:23], v[100:103]
    s_waitcnt vmcnt(3)
    v_cmp_eq_u32 vcc, -1, v39
    ds_read_b64 v[20:21], v7 offset:40960
    ds_read_b64 v[22:23], v7 offset:45056
    v_mfma_f32_16x16x32_bf16 v[104:107], v[32:35], a[24:27], v[104:107]
    ds_read_b64 v[24:25], v7 offset:49152
    ds_read_b64 v[26:27], v7 offset:53248
    v_mfma_f32_16x16x32_bf16 v[108:111], v[32:35], a[28:31], v[108:111]
    ds_read_b64 v[28:29], v7 offset:57344
    ds_read_b64 v[30:31], v7 offset:61440
    s_cbranch_vccnz G_c57_r
G_c57:
    v_mfma_f32_16x16x32_bf16 v[96:99], v[36:39], a[32:35], v[96:99]
    s_waitcnt lgkmcnt(4)
    v_add_f32 v16, v16, v18
    v_add_f32 v17, v17, v19
    v_add_f32 v20, v20, v22
    v_add_f32 v21, v21, v23
    v_mfma_f32_16x16x32_bf16 v[100:103], v[36:39], a[36:39], v[100:103]
    s_waitcnt vmcnt(2)
    v_cmp_eq_u32 vcc, -1, v43
    s_waitcnt lgkmcnt(0)
    v_add_f32 v24, v24, v26
    v_add_f32 v25, v25, v27
    v_add_f32 v28, v28, v30
    v_add_f32 v29, v29, v31
    v_mfma_f32_16x16x32_bf16 v[104:107], v[36:39], a[40:43], v[104:107]
    v_add_f32 v16, v16, v20
    v_add_f32 v17, v17, v21
    v_add_f32 v24, v24, v28
    v_add_f32 v25, v25, v29
    v_mfma_f32_16x16x32_bf16 v[108:111], v[36:39], a[44:47], v[108:111]
    v_add_f32 v126, v16, v24
    v_add_f32 v127, v17, v25
    v_add_f32 v126, v126, v5
    v_add_f32 v127, v127, v11
    s_cbranch_vccnz G_c58_r
G_c58:
    v_mfma_f32_16x16x32_bf16 v[96:99], v[40:43], a[48:51], v[96:99]
    v_cvt_pk_bf16_f32 v118, v126, v127
    buffer_store_dword v118, v10, s[32:35], 0 offen offset:64
    v_mfma_f32_16x16x32_bf16 v[100:103], v[40:43], a[52:55], v[100:103]
    s_waitcnt vmcnt(1)
    v_cmp_eq_u32 vcc, -1, v47
    v_mfma_f32_16x16x32_bf16 v[104:107], v[40:43], a[56:59], v[104:107]
    v_mfma_f32_16x16x32_bf16 v[108:111], v[40:43], a[60:63], v[108:111]
    s_cbranch_vccnz G_c59_r
G_c59:
    v_mfma_f32_16x16x32_bf16 v[96:99], v[44:47], a[64:67], v[96:99]
    v_mfma_f32_16x16x32_bf16 v[100:103], v[44:47], a[68:71], v[100:103]
    v_mfma_f32_16x16x32_bf16 v[104:107], v[44:47], a[72:75], v[104:107]
    v_mfma_f32_16x16x32_bf16 v[108:111], v[44:47], a[76:79], v[108:111]
    v_lshlrev_b32 v5, 16, v119
    v_and_b32 v11, 0xffff0000, v119
    v_add_f32 v5, v5, v114
    v_add_f32 v11, v11, v114
    s_nop 0
    ds_write_b128 v6, v[96:99] offset:0
    ds_write_b128 v6, v[100:103] offset:1024
    ds_write_b128 v6, v[104:107] offset:2048
    ds_write_b128 v6, v[108:111] offset:3072
    s_waitcnt lgkmcnt(0)
    s_barrier
    ds_read_b64 v[96:97], v7 offset:0
    ds_read_b64 v[98:99], v7 offset:4096
    ds_read_b64 v[100:101], v7 offset:8192
    ds_read_b64 v[102:103], v7 offset:12288
    ds_read_b64 v[104:105], v7 offset:16384
    ds_read_b64 v[106:107], v7 offset:20480
    ds_read_b64 v[108:109], v7 offset:24576
    ds_read_b64 v[110:111], v7 offset:28672
    s_waitcnt lgkmcnt(4)
    v_pk_add_f32 v[96:97], v[96:97], v[98:99]
    v_pk_add_f32 v[100:101], v[100:101], v[102:103]
    s_waitcnt lgkmcnt(0)
    v_pk_add_f32 v[104:105], v[104:105], v[106:107]
    v_pk_add_f32 v[108:109], v[108:109], v[110:111]
    v_pk_add_f32 v[96:97], v[96:97], v[100:101]
    v_pk_add_f32 v[104:105], v[104:105], v[108:109]
    v_pk_add_f32 v[126:127], v[96:97], v[104:105]
    v_add_f32 v126, v126, v5
    v_add_f32 v127, v127, v11
    v_cvt_pk_bf16_f32 v119, v126, v127
    buffer_store_dword v119, v10, s[32:35], 0 offen offset:96
L_end:
    s_endpgm
P2_idl:
    s_and_b32 s66, s45, 3
    s_lshl3_add_u32 s66, s66, s3
    s_mul_i32 s66, s66, 229376
    s_lshl_b32 s67, s44, 9
    s_add_u32 s66, s66, s67
    v_lshrrev_b32 v5, 5, v0
    v_mul_u32_u24 v5, 3584, v5
    v_add3_u32 v5, v5, v4, s66
    v_add_u32 v6, 7168, v5
    s_branch P2_idl_e
F1_far:
    s_add_u32 s68, s83, 128
    s_mov_b64 exec, 1
    buffer_store_dword v18, off, s[40:43], s68 sc1
    s_mov_b32 exec_lo, -1
    s_add_u32 s66, s84, 128
    buffer_load_dword v16, v19, s[40:43], s66 offen sc1
    s_waitcnt vmcnt(0)
    s_sub_u32 s52, s52, 1
    s_cbranch_scc1 F1_giveup
    v_cmp_eq_u32 vcc, 0, v16
    s_cbranch_vccnz F1_p
    v_and_b32 v16, 15, v16
    v_cmp_ne_u32 vcc, s1, v16
    s_cbranch_vccz F1_p
    buffer_wbl2 sc1
    s_waitcnt vmcnt(0)
    v_or_b32 v17, 16, v18
    s_mov_b64 exec, 1
    buffer_store_dword v17, off, s[40:43], s68 sc1
    s_mov_b32 exec_lo, -1
F1_w:
    buffer_load_dword v16, v19, s[40:43], s66 offen sc1
    s_waitcnt vmcnt(0)
    v_cmp_gt_u32 vcc, 16, v16
    s_cbranch_vccz F1_w_ok
    s_sub_u32 s52, s52, 1
    s_cbranch_scc0 F1_w
    s_mov_b32 s52, 0
F1_w_ok:
    buffer_inv sc1
F1_fin:
    v_mov_b32 v16, 0
    ds_write_b32 v110, v16
    s_waitcnt vmcnt(0) lgkmcnt(0)
    s_branch F1_ok
F1_giveup:
    s_mov_b32 s52, 0
    s_branch F1_fin
P2_cw:
    buffer_load_dword v112, v4, s[40:43], s80 offen sc1
    buffer_load_dword v116, off, s[40:43], s80 sc1
    s_branch P2_cw_e
P2_g_r:
    buffer_load_dword v124, v4, s[36:39], 0 offen sc1
    s_waitcnt vmcnt(0)
    buffer_load_dword v112, v4, s[40:43], s80 offen sc1
    s_waitcnt vmcnt(0)
    s_sub_u32 s52, s52, 1
    s_cbranch_scc0 P2_g
    s_mov_b32 s52, 0
    s_branch P2_g_ok
P2_slow:
    s_waitcnt vmcnt(0)
    s_lshl_b32 s66, s47, 17
    s_add_u32 s66, s66, 0x200000
    s_mov_b32 s67, s66
    s_add_u32 s68, s66, 0x20000
    v_mov_b32 v48, 0xff800000
P2_s1:
    buffer_load_dwordx4 v[80:83], v4, s[40:43], s67 offen sc1
    s_add_u32 s67, s67, 2048
    s_waitcnt vmcnt(0)
    v_mfma_f32_32x32x16_bf16 v[16:31], v[80:83], v[12:15], 0
    s_nop 11
    v_max3_f32 v48, v48, v16, v17
    v_max3_f32 v48, v48, v18, v19
    v_max3_f32 v48, v48, v20, v21
    v_max3_f32 v48, v48, v22, v23
    v_max3_f32 v48, v48, v24, v25
    v_max3_f32 v48, v48, v26, v27
    v_max3_f32 v48, v48, v28, v29
    v_max3_f32 v48, v48, v30, v31
    s_cmp_lt_u32 s67, s68
    s_cbranch_scc1 P2_s1
    v_mov_b32 v49, v48
    s_nop 1
    v_permlane32_swap_b32 v48, v49
    s_nop 1
    v_max_f32 v48, v48, v49
    v_and_b32 v1, 15, v0
    v_lshrrev_b32 v2, 5, v0
    v_lshlrev_b32 v2, 8, v2
    v_lshl_add_u32 v1, v1, 4, v2
    v_sub_f32 v32, 0, v48
    v_sub_f32 v33, 0, v48
    v_sub_f32 v34, 0, v48
    v_sub_f32 v35, 0, v48
    v_sub_f32 v36, 0, v48
    v_sub_f32 v37, 0, v48
    v_sub_f32 v38, 0, v48
    v_sub_f32 v39, 0, v48
    v_sub_f32 v40, 0, v48
    v_sub_f32 v41, 0, v48
    v_sub_f32 v42, 0, v48
    v_sub_f32 v43, 0, v48
    v_sub_f32 v44, 0, v48
    v_sub_f32 v45, 0, v48
    v_sub_f32 v46, 0, v48
    v_sub_f32 v47, 0, v48
    v_mov_b32 v64, 0
    v_mov_b32 v65, 0
    v_mov_b32 v66, 0
    v_mov_b32 v67, 0
    v_mov_b32 v68, 0
    v_mov_b32 v69, 0
    v_mov_b32 v70, 0
    v_mov_b32 v71, 0
    v_mov_b32 v72, 0
    v_mov_b32 v73, 0
    v_mov_b32 v74, 0
    v_mov_b32 v75, 0
    v_mov_b32 v76, 0
    v_mov_b32 v77, 0
    v_mov_b32 v78, 0
    v_mov_b32 v79, 0
    v_mov_b32 v84, 0x3f803f80
    v_mov_b32 v85, 0x3f803f80
    v_mov_b32 v86, 0x3f803f80
    v_mov_b32 v87, 0x3f803f80
    v_mov_b32 v88, 0x3f803f80
    v_mov_b32 v89, 0x3f803f80
    v_mov_b32 v90, 0x3f803f80
    v_mov_b32 v91, 0x3f803f80
    s_mov_b32 s67, s66
P2_s2:
    buffer_load_dwordx4 v[80:83], v4, s[40:43], s67 offen sc1
    s_mov_b32 exec_lo, 0xffff
    s_mov_b32 exec_hi, 0xffff
    buffer_load_dwordx4 v[84:87], v1, s[40:43], s67 offen offset:1024 sc1
    buffer_load_dwordx4 v[88:91], v1, s[40:43], s67 offen offset:1536 sc1
    s_mov_b64 exec, -1
    s_add_u32 s67, s67, 2048
    s_waitcnt vmcnt(0)
    v_mfma_f32_32x32x16_bf16 v[16:31], v[80:83], v[12:15], v[32:47]
    s_nop 11
    v_exp_f32 v16, v16
    v_exp_f32 v17, v17
    v_exp_f32 v18, v18
    v_exp_f32 v19, v19
    v_exp_f32 v20, v20
    v_exp_f32 v21, v21
    v_exp_f32 v22, v22
    v_exp_f32 v23, v23
    v_exp_f32 v24, v24
    v_exp_f32 v25, v25
    v_exp_f32 v26, v26
    v_exp_f32 v27, v27
    v_exp_f32 v28, v28
    v_exp_f32 v29, v29
    v_exp_f32 v30, v30
    v_exp_f32 v31, v31
    s_nop 1
    v_smfmac_f32_32x32x32_bf16 v[64:79], v[84:87], v[16:23], v7
    v_smfmac_f32_32x32x32_bf16 v[64:79], v[88:91], v[24:31], v7
    s_cmp_lt_u32 s67, s68
    s_cbranch_scc1 P2_s2
    s_nop 11
    v_rcp_f32 v28, v72
    s_branch P2_fin
P3_w0:
    ds_read_b32 v1, v2
    s_waitcnt lgkmcnt(0)
    s_sub_u32 s52, s52, 1
    s_cbranch_scc0 P3_c0
    s_mov_b32 s52, 0
    s_branch P3_d0
P3_w1:
    ds_read_b32 v1, v2
    s_waitcnt lgkmcnt(0)
    s_sub_u32 s52, s52, 1
    s_cbranch_scc0 P3_c1
    s_mov_b32 s52, 0
    s_branch P3_d1
P3_w2:
    ds_read_b32 v1, v2
    s_waitcnt lgkmcnt(0)
    s_sub_u32 s52, s52, 1
    s_cbranch_scc0 P3_c2
    s_mov_b32 s52, 0
    s_branch P3_d2
P3_w3:
    ds_read_b32 v1, v2
    s_waitcnt lgkmcnt(0)
    s_sub_u32 s52, s52, 1
    s_cbranch_scc0 P3_c3
    s_mov_b32 s52, 0
    s_branch P3_d3
P3_w4:
    ds_read_b32 v1, v2
    s_waitcnt lgkmcnt(0)
    s_sub_u32 s52, s52, 1
    s_cbranch_scc0 P3_c4
    s_mov_b32 s52, 0
    s_branch P3_d4
P3_w5:
    ds_read_b32 v1, v2
    s_waitcnt lgkmcnt(0)
    s_sub_u32 s52, s52, 1
    s_cbranch_scc0 P3_c5
    s_mov_b32 s52, 0
    s_branch P3_d5
P3_w6:
    ds_read_b32 v1, v2
    s_waitcnt lgkmcnt(0)
    s_sub_u32 s52, s52, 1
    s_cbranch_scc0 P3_c6
    s_mov_b32 s52, 0
    s_branch P3_d6
P3_w7:
    ds_read_b32 v1, v2
    s_waitcnt lgkmcnt(0)
    s_sub_u32 s52, s52, 1
    s_cbranch_scc0 P3_c7
    s_mov_b32 s52, 0
    s_branch P3_d7
P3_sg:
    buffer_store_dwordx2 v[6:7], v12, s[40:43], s74 offen sc1
    s_branch P3_se
G_c0_r:
    buffer_load_dwordx4 v[32:35], v124, s[40:43], s72 offen offset:0 sc1
    buffer_load_dwordx4 v[36:39], v124, s[40:43], s72 offen offset:1024 sc1
    buffer_load_dwordx4 v[40:43], v124, s[40:43], s72 offen offset:2048 sc1
    buffer_load_dwordx4 v[44:47], v124, s[40:43], s72 offen offset:3072 sc1
    buffer_load_dwordx4 v[48:51], v124, s[40:43], s73 offen offset:0 sc1
    buffer_load_dwordx4 v[52:55], v124, s[40:43], s73 offen offset:1024 sc1
    buffer_load_dwordx4 v[56:59], v124, s[40:43], s73 offen offset:2048 sc1
    buffer_load_dwordx4 v[60:63], v124, s[40:43], s73 offen offset:3072 sc1
    s_waitcnt vmcnt(0)
    v_cmp_eq_u32 vcc, -1, v35
    s_cbranch_vccz G_c0
    s_sub_u32 s52, s52, 1
    s_cbranch_scc0 G_c0_r
    s_mov_b32 s52, 0
    s_branch G_c0
G_c1_r:
    buffer_load_dwordx4 v[36:39], v124, s[40:43], s72 offen offset:1024 sc1
    buffer_load_dwordx4 v[40:43], v124, s[40:43], s72 offen offset:2048 sc1
    buffer_load_dwordx4 v[44:47], v124, s[40:43], s72 offen offset:3072 sc1
    buffer_load_dwordx4 v[48:51], v124, s[40:43], s73 offen offset:0 sc1
    buffer_load_dwordx4 v[52:55], v124, s[40:43], s73 offen offset:1024 sc1
    buffer_load_dwordx4 v[56:59], v124, s[40:43], s73 offen offset:2048 sc1
    buffer_load_dwordx4 v[60:63], v124, s[40:43], s73 offen offset:3072 sc1
    s_waitcnt vmcnt(0)
    v_cmp_eq_u32 vcc, -1, v39
    s_cbranch_vccz G_c1
    s_sub_u32 s52, s52, 1
    s_cbranch_scc0 G_c1_r
    s_mov_b32 s52, 0
    s_branch G_c1
G_c2_r:
    buffer_load_dwordx4 v[40:43], v124, s[40:43], s72 offen offset:2048 sc1
    buffer_load_dwordx4 v[44:47], v124, s[40:43], s72 offen offset:3072 sc1
    buffer_load_dwordx4 v[48:51], v124, s[40:43], s73 offen offset:0 sc1
    buffer_load_dwordx4 v[52:55], v124, s[40:43], s73 offen offset:1024 sc1
    buffer_load_dwordx4 v[56:59], v124, s[40:43], s73 offen offset:2048 sc1
    buffer_load_dwordx4 v[60:63], v124, s[40:43], s73 offen offset:3072 sc1
    s_waitcnt vmcnt(0)
    v_cmp_eq_u32 vcc, -1, v43
    s_cbranch_vccz G_c2
    s_sub_u32 s52, s52, 1
    s_cbranch_scc0 G_c2_r
    s_mov_b32 s52, 0
    s_branch G_c2
G_c3_r:
    buffer_load_dwordx4 v[44:47], v124, s[40:43], s72 offen offset:3072 sc1
    buffer_load_dwordx4 v[48:51], v124, s[40:43], s73 offen offset:0 sc1
    buffer_load_dwordx4 v[52:55], v124, s[40:43], s73 offen offset:1024 sc1
    buffer_load_dwordx4 v[56:59], v124, s[40:43], s73 offen offset:2048 sc1
    buffer_load_dwordx4 v[60:63], v124, s[40:43], s73 offen offset:3072 sc1
    s_waitcnt vmcnt(0)
    v_cmp_eq_u32 vcc, -1, v47
    s_cbranch_vccz G_c3
    s_sub_u32 s52, s52, 1
    s_cbranch_scc0 G_c3_r
    s_mov_b32 s52, 0
    s_branch G_c3
G_c4_r:
    buffer_load_dwordx4 v[48:51], v124, s[40:43], s73 offen offset:0 sc1
    buffer_load_dwordx4 v[52:55], v124, s[40:43], s73 offen offset:1024 sc1
    buffer_load_dwordx4 v[56:59], v124, s[40:43], s73 offen offset:2048 sc1
    buffer_load_dwordx4 v[60:63], v124, s[40:43], s73 offen offset:3072 sc1
    s_waitcnt vmcnt(0)
    v_cmp_eq_u32 vcc, -1, v51
    s_cbranch_vccz G_c4
    s_sub_u32 s52, s52, 1
    s_cbranch_scc0 G_c4_r
    s_mov_b32 s52, 0
    s_branch G_c4
G_c5_r:
    buffer_load_dwordx4 v[52:55], v124, s[40:43], s73 offen offset:1024 sc1
    buffer_load_dwordx4 v[56:59], v124, s[40:43], s73 offen offset:2048 sc1
    buffer_load_dwordx4 v[60:63], v124, s[40:43], s73 offen offset:3072 sc1
    s_waitcnt vmcnt(0)
    v_cmp_eq_u32 vcc, -1, v55
    s_cbranch_vccz G_c5
    s_sub_u32 s52, s52, 1
    s_cbranch_scc0 G_c5_r
    s_mov_b32 s52, 0
    s_branch G_c5
G_c6_r:
    buffer_load_dwordx4 v[56:59], v124, s[40:43], s73 offen offset:2048 sc1
    buffer_load_dwordx4 v[60:63], v124, s[40:43], s73 offen offset:3072 sc1
    s_waitcnt vmcnt(0)
    v_cmp_eq_u32 vcc, -1, v59
    s_cbranch_vccz G_c6
    s_sub_u32 s52, s52, 1
    s_cbranch_scc0 G_c6_r
    s_mov_b32 s52, 0
    s_branch G_c6
G_c7_r:
    buffer_load_dwordx4 v[60:63], v124, s[40:43], s73 offen offset:3072 sc1
    s_waitcnt vmcnt(0)
    v_cmp_eq_u32 vcc, -1, v63
    s_cbranch_vccz G_c7
    s_sub_u32 s52, s52, 1
    s_cbranch_scc0 G_c7_r
    s_mov_b32 s52, 0
    s_branch G_c7
G_c8_r:
    buffer_load_dwordx4 v[32:35], v125, s[40:43], s72 offen offset:0 sc1
    s_waitcnt vmcnt(0)
    v_cmp_eq_u32 vcc, -1, v35
    s_cbranch_vccz G_c8
    s_sub_u32 s52, s52, 1
    s_cbranch_scc0 G_c8_r
    s_mov_b32 s52, 0
    s_branch G_c8
G_c9_r:
    buffer_load_dwordx4 v[36:39], v125, s[40:43], s72 offen offset:1024 sc1
    s_waitcnt vmcnt(0)
    v_cmp_eq_u32 vcc, -1, v39
    s_cbranch_vccz G_c9
    s_sub_u32 s52, s52, 1
    s_cbranch_scc0 G_c9_r
    s_mov_b32 s52, 0
    s_branch G_c9
G_c10_r:
    buffer_load_dwordx4 v[40:43], v125, s[40:43], s72 offen offset:2048 sc1
    s_waitcnt vmcnt(0)
    v_cmp_eq_u32 vcc, -1, v43
    s_cbranch_vccz G_c10
    s_sub_u32 s52, s52, 1
    s_cbranch_scc0 G_c10_r
    s_mov_b32 s52, 0
    s_branch G_c10
G_c11_r:
    buffer_load_dwordx4 v[44:47], v125, s[40:43], s72 offen offset:3072 sc1
    s_waitcnt vmcnt(0)
    v_cmp_eq_u32 vcc, -1, v47
    s_cbranch_vccz G_c11
    s_sub_u32 s52, s52, 1
    s_cbranch_scc0 G_c11_r
    s_mov_b32 s52, 0
    s_branch G_c11
G_c12_r:
    buffer_load_dwordx4 v[48:51], v125, s[40:43], s73 offen offset:0 sc1
    s_waitcnt vmcnt(0)
    v_cmp_eq_u32 vcc, -1, v51
    s_cbranch_vccz G_c12
    s_sub_u32 s52, s52, 1
    s_cbranch_scc0 G_c12_r
    s_mov_b32 s52, 0
    s_branch G_c12
G_c13_r:
    buffer_load_dwordx4 v[52:55], v125, s[40:43], s73 offen offset:1024 sc1
    s_waitcnt vmcnt(0)
    v_cmp_eq_u32 vcc, -1, v55
    s_cbranch_vccz G_c13
    s_sub_u32 s52, s52, 1
    s_cbranch_scc0 G_c13_r
    s_mov_b32 s52, 0
    s_branch G_c13
G_c14_r:
    buffer_load_dwordx4 v[56:59], v125, s[40:43], s73 offen offset:2048 sc1
    s_waitcnt vmcnt(0)
    v_cmp_eq_u32 vcc, -1, v59
    s_cbranch_vccz G_c14
    s_sub_u32 s52, s52, 1
    s_cbranch_scc0 G_c14_r
    s_mov_b32 s52, 0
    s_branch G_c14
G_c15_r:
    buffer_load_dwordx4 v[60:63], v125, s[40:43], s73 offen offset:3072 sc1
    s_waitcnt vmcnt(0)
    v_cmp_eq_u32 vcc, -1, v63
    s_cbranch_vccz G_c15
    s_sub_u32 s52, s52, 1
    s_cbranch_scc0 G_c15_r
    s_mov_b32 s52, 0
    s_branch G_c15
G_c16_r:
    buffer_load_dwordx4 v[32:35], v124, s[40:43], s72 offen offset:0 sc1
    s_waitcnt vmcnt(0)
    v_cmp_eq_u32 vcc, -1, v35
    s_cbranch_vccz G_c16
    s_sub_u32 s52, s52, 1
    s_cbranch_scc0 G_c16_r
    s_mov_b32 s52, 0
    s_branch G_c16
G_c17_r:
    buffer_load_dwordx4 v[36:39], v124, s[40:43], s72 offen offset:1024 sc1
    s_waitcnt vmcnt(0)
    v_cmp_eq_u32 vcc, -1, v39
    s_cbranch_vccz G_c17
    s_sub_u32 s52, s52, 1
    s_cbranch_scc0 G_c17_r
    s_mov_b32 s52, 0
    s_branch G_c17
G_c18_r:
    buffer_load_dwordx4 v[40:43], v124, s[40:43], s72 offen offset:2048 sc1
    s_waitcnt vmcnt(0)
    v_cmp_eq_u32 vcc, -1, v43
    s_cbranch_vccz G_c18
    s_sub_u32 s52, s52, 1
    s_cbranch_scc0 G_c18_r
    s_mov_b32 s52, 0
    s_branch G_c18
G_c19_r:
    buffer_load_dwordx4 v[44:47], v124, s[40:43], s72 offen offset:3072 sc1
    s_waitcnt vmcnt(0)
    v_cmp_eq_u32 vcc, -1, v47
    s_cbranch_vccz G_c19
    s_sub_u32 s52, s52, 1
    s_cbranch_scc0 G_c19_r
    s_mov_b32 s52, 0
    s_branch G_c19
G_c20_r:
    buffer_load_dwordx4 v[48:51], v124, s[40:43], s73 offen offset:0 sc1
    s_waitcnt vmcnt(0)
    v_cmp_eq_u32 vcc, -1, v51
    s_cbranch_vccz G_c20
    s_sub_u32 s52, s52, 1
    s_cbranch_scc0 G_c20_r
    s_mov_b32 s52, 0
    s_branch G_c20
G_c21_r:
    buffer_load_dwordx4 v[52:55], v124, s[40:43], s73 offen offset:1024 sc1
    s_waitcnt vmcnt(0)
    v_cmp_eq_u32 vcc, -1, v55
    s_cbranch_vccz G_c21
    s_sub_u32 s52, s52, 1
    s_cbranch_scc0 G_c21_r
    s_mov_b32 s52, 0
    s_branch G_c21
G_c22_r:
    buffer_load_dwordx4 v[56:59], v124, s[40:43], s73 offen offset:2048 sc1
    s_waitcnt vmcnt(0)
    v_cmp_eq_u32 vcc, -1, v59
    s_cbranch_vccz G_c22
    s_sub_u32 s52, s52, 1
    s_cbranch_scc0 G_c22_r
    s_mov_b32 s52, 0
    s_branch G_c22
G_c23_r:
    buffer_load_dwordx4 v[60:63], v124, s[40:43], s73 offen offset:3072 sc1
    s_waitcnt vmcnt(0)
    v_cmp_eq_u32 vcc, -1, v63
    s_cbranch_vccz G_c23
    s_sub_u32 s52, s52, 1
    s_cbranch_scc0 G_c23_r
    s_mov_b32 s52, 0
    s_branch G_c23
G_c24_r:
    buffer_load_dwordx4 v[32:35], v125, s[40:43], s72 offen offset:0 sc1
    s_waitcnt vmcnt(0)
    v_cmp_eq_u32 vcc, -1, v35
    s_cbranch_vccz G_c24
    s_sub_u32 s52, s52, 1
    s_cbranch_scc0 G_c24_r
    s_mov_b32 s52, 0
    s_branch G_c24
G_c25_r:
    buffer_load_dwordx4 v[36:39], v125, s[40:43], s72 offen offset:1024 sc1
    s_waitcnt vmcnt(0)
    v_cmp_eq_u32 vcc, -1, v39
    s_cbranch_vccz G_c25
    s_sub_u32 s52, s52, 1
    s_cbranch_scc0 G_c25_r
    s_mov_b32 s52, 0
    s_branch G_c25
G_c26_r:
    buffer_load_dwordx4 v[40:43], v125, s[40:43], s72 offen offset:2048 sc1
    s_waitcnt vmcnt(0)
    v_cmp_eq_u32 vcc, -1, v43
    s_cbranch_vccz G_c26
    s_sub_u32 s52, s52, 1
    s_cbranch_scc0 G_c26_r
    s_mov_b32 s52, 0
    s_branch G_c26
G_c27_r:
    buffer_load_dwordx4 v[44:47], v125, s[40:43], s72 offen offset:3072 sc1
    s_waitcnt vmcnt(0)
    v_cmp_eq_u32 vcc, -1, v47
    s_cbranch_vccz G_c27
    s_sub_u32 s52, s52, 1
    s_cbranch_scc0 G_c27_r
    s_mov_b32 s52, 0
    s_branch G_c27
G_c28_r:
    buffer_load_dwordx4 v[48:51], v125, s[40:43], s73 offen offset:0 sc1
    s_waitcnt vmcnt(0)
    v_cmp_eq_u32 vcc, -1, v51
    s_cbranch_vccz G_c28
    s_sub_u32 s52, s52, 1
    s_cbranch_scc0 G_c28_r
    s_mov_b32 s52, 0
    s_branch G_c28
G_c29_r:
    buffer_load_dwordx4 v[52:55], v125, s[40:43], s73 offen offset:1024 sc1
    s_waitcnt vmcnt(0)
    v_cmp_eq_u32 vcc, -1, v55
    s_cbranch_vccz G_c29
    s_sub_u32 s52, s52, 1
    s_cbranch_scc0 G_c29_r
    s_mov_b32 s52, 0
    s_branch G_c29
G_c30_r:
    buffer_load_dwordx4 v[56:59], v125, s[40:43], s73 offen offset:2048 sc1
    s_waitcnt vmcnt(0)
    v_cmp_eq_u32 vcc, -1, v59
    s_cbranch_vccz G_c30
    s_sub_u32 s52, s52, 1
    s_cbranch_scc0 G_c30_r
    s_mov_b32 s52, 0
    s_branch G_c30
G_c31_r:
    buffer_load_dwordx4 v[60:63], v125, s[40:43], s73 offen offset:3072 sc1
    s_waitcnt vmcnt(0)
    v_cmp_eq_u32 vcc, -1, v63
    s_cbranch_vccz G_c31
    s_sub_u32 s52, s52, 1
    s_cbranch_scc0 G_c31_r
    s_mov_b32 s52, 0
    s_branch G_c31
G_c32_r:
    buffer_load_dwordx4 v[32:35], v124, s[40:43], s74 offen offset:0 sc1
    s_waitcnt vmcnt(0)
    v_cmp_eq_u32 vcc, -1, v35
    s_cbranch_vccz G_c32
    s_sub_u32 s52, s52, 1
    s_cbranch_scc0 G_c32_r
    s_mov_b32 s52, 0
    s_branch G_c32
G_c33_r:
    buffer_load_dwordx4 v[36:39], v124, s[40:43], s74 offen offset:1024 sc1
    s_waitcnt vmcnt(0)
    v_cmp_eq_u32 vcc, -1, v39
    s_cbranch_vccz G_c33
    s_sub_u32 s52, s52, 1
    s_cbranch_scc0 G_c33_r
    s_mov_b32 s52, 0
    s_branch G_c33
G_c34_r:
    buffer_load_dwordx4 v[40:43], v124, s[40:43], s74 offen offset:2048 sc1
    s_waitcnt vmcnt(0)
    v_cmp_eq_u32 vcc, -1, v43
    s_cbranch_vccz G_c34
    s_sub_u32 s52, s52, 1
    s_cbranch_scc0 G_c34_r
    s_mov_b32 s52, 0
    s_branch G_c34
G_c35_r:
    buffer_load_dwordx4 v[44:47], v124, s[40:43], s74 offen offset:3072 sc1
    s_waitcnt vmcnt(0)
    v_cmp_eq_u32 vcc, -1, v47
    s_cbranch_vccz G_c35
    s_sub_u32 s52, s52, 1
    s_cbranch_scc0 G_c35_r
    s_mov_b32 s52, 0
    s_branch G_c35
G_c36_r:
    buffer_load_dwordx4 v[48:51], v124, s[40:43], s75 offen offset:0 sc1
    s_waitcnt vmcnt(0)
    v_cmp_eq_u32 vcc, -1, v51
    s_cbranch_vccz G_c36
    s_sub_u32 s52, s52, 1
    s_cbranch_scc0 G_c36_r
    s_mov_b32 s52, 0
    s_branch G_c36
G_c37_r:
    buffer_load_dwordx4 v[52:55], v124, s[40:43], s75 offen offset:1024 sc1
    s_waitcnt vmcnt(0)
    v_cmp_eq_u32 vcc, -1, v55
    s_cbranch_vccz G_c37
    s_sub_u32 s52, s52, 1
    s_cbranch_scc0 G_c37_r
    s_mov_b32 s52, 0
    s_branch G_c37
G_c38_r:
    buffer_load_dwordx4 v[56:59], v124, s[40:43], s75 offen offset:2048 sc1
    s_waitcnt vmcnt(0)
    v_cmp_eq_u32 vcc, -1, v59
    s_cbranch_vccz G_c38
    s_sub_u32 s52, s52, 1
    s_cbranch_scc0 G_c38_r
    s_mov_b32 s52, 0
    s_branch G_c38
G_c39_r:
    buffer_load_dwordx4 v[60:63], v125, s[40:43], s74 offen offset:0 sc1
    s_waitcnt vmcnt(0)
    v_cmp_eq_u32 vcc, -1, v63
    s_cbranch_vccz G_c39
    s_sub_u32 s52, s52, 1
    s_cbranch_scc0 G_c39_r
    s_mov_b32 s52, 0
    s_branch G_c39
G_c40_r:
    buffer_load_dwordx4 v[32:35], v125, s[40:43], s74 offen offset:1024 sc1
    s_waitcnt vmcnt(0)
    v_cmp_eq_u32 vcc, -1, v35
    s_cbranch_vccz G_c40
    s_sub_u32 s52, s52, 1
    s_cbranch_scc0 G_c40_r
    s_mov_b32 s52, 0
    s_branch G_c40
G_c41_r:
    buffer_load_dwordx4 v[36:39], v125, s[40:43], s74 offen offset:2048 sc1
    s_waitcnt vmcnt(0)
    v_cmp_eq_u32 vcc, -1, v39
    s_cbranch_vccz G_c41
    s_sub_u32 s52, s52, 1
    s_cbranch_scc0 G_c41_r
    s_mov_b32 s52, 0
    s_branch G_c41
G_c42_r:
    buffer_load_dwordx4 v[40:43], v125, s[40:43], s74 offen offset:3072 sc1
    s_waitcnt vmcnt(0)
    v_cmp_eq_u32 vcc, -1, v43
    s_cbranch_vccz G_c42
    s_sub_u32 s52, s52, 1
    s_cbranch_scc0 G_c42_r
    s_mov_b32 s52, 0
    s_branch G_c42
G_c43_r:
    buffer_load_dwordx4 v[44:47], v125, s[40:43], s75 offen offset:0 sc1
    s_waitcnt vmcnt(0)
    v_cmp_eq_u32 vcc, -1, v47
    s_cbranch_vccz G_c43
    s_sub_u32 s52, s52, 1
    s_cbranch_scc0 G_c43_r
    s_mov_b32 s52, 0
    s_branch G_c43
G_c44_r:
    buffer_load_dwordx4 v[48:51], v125, s[40:43], s75 offen offset:1024 sc1
    s_waitcnt vmcnt(0)
    v_cmp_eq_u32 vcc, -1, v51
    s_cbranch_vccz G_c44
    s_sub_u32 s52, s52, 1
    s_cbranch_scc0 G_c44_r
    s_mov_b32 s52, 0
    s_branch G_c44
G_c45_r:
    buffer_load_dwordx4 v[52:55], v125, s[40:43], s75 offen offset:2048 sc1
    s_waitcnt vmcnt(0)
    v_cmp_eq_u32 vcc, -1, v55
    s_cbranch_vccz G_c45
    s_sub_u32 s52, s52, 1
    s_cbranch_scc0 G_c45_r
    s_mov_b32 s52, 0
    s_branch G_c45
G_c46_r:
    buffer_load_dwordx4 v[56:59], v124, s[40:43], s74 offen offset:0 sc1
    s_waitcnt vmcnt(0)
    v_cmp_eq_u32 vcc, -1, v59
    s_cbranch_vccz G_c46
    s_sub_u32 s52, s52, 1
    s_cbranch_scc0 G_c46_r
    s_mov_b32 s52, 0
    s_branch G_c46
G_c47_r:
    buffer_load_dwordx4 v[60:63], v124, s[40:43], s74 offen offset:1024 sc1
    s_waitcnt vmcnt(0)
    v_cmp_eq_u32 vcc, -1, v63
    s_cbranch_vccz G_c47
    s_sub_u32 s52, s52, 1
    s_cbranch_scc0 G_c47_r
    s_mov_b32 s52, 0
    s_branch G_c47
G_c48_r:
    buffer_load_dwordx4 v[32:35], v124, s[40:43], s74 offen offset:2048 sc1
    s_waitcnt vmcnt(0)
    v_cmp_eq_u32 vcc, -1, v35
    s_cbranch_vccz G_c48
    s_sub_u32 s52, s52, 1
    s_cbranch_scc0 G_c48_r
    s_mov_b32 s52, 0
    s_branch G_c48
G_c49_r:
    buffer_load_dwordx4 v[36:39], v124, s[40:43], s74 offen offset:3072 sc1
    s_waitcnt vmcnt(0)
    v_cmp_eq_u32 vcc, -1, v39
    s_cbranch_vccz G_c49
    s_sub_u32 s52, s52, 1
    s_cbranch_scc0 G_c49_r
    s_mov_b32 s52, 0
    s_branch G_c49
G_c50_r:
    buffer_load_dwordx4 v[40:43], v124, s[40:43], s75 offen offset:0 sc1
    s_waitcnt vmcnt(0)
    v_cmp_eq_u32 vcc, -1, v43
    s_cbranch_vccz G_c50
    s_sub_u32 s52, s52, 1
    s_cbranch_scc0 G_c50_r
    s_mov_b32 s52, 0
    s_branch G_c50
G_c51_r:
    buffer_load_dwordx4 v[44:47], v124, s[40:43], s75 offen offset:1024 sc1
    s_waitcnt vmcnt(0)
    v_cmp_eq_u32 vcc, -1, v47
    s_cbranch_vccz G_c51
    s_sub_u32 s52, s52, 1
    s_cbranch_scc0 G_c51_r
    s_mov_b32 s52, 0
    s_branch G_c51
G_c52_r:
    buffer_load_dwordx4 v[48:51], v124, s[40:43], s75 offen offset:2048 sc1
    s_waitcnt vmcnt(0)
    v_cmp_eq_u32 vcc, -1, v51
    s_cbranch_vccz G_c52
    s_sub_u32 s52, s52, 1
    s_cbranch_scc0 G_c52_r
    s_mov_b32 s52, 0
    s_branch G_c52
G_c53_r:
    buffer_load_dwordx4 v[52:55], v125, s[40:43], s74 offen offset:0 sc1
    s_waitcnt vmcnt(0)
    v_cmp_eq_u32 vcc, -1, v55
    s_cbranch_vccz G_c53
    s_sub_u32 s52, s52, 1
    s_cbranch_scc0 G_c53_r
    s_mov_b32 s52, 0
    s_branch G_c53
G_c54_r:
    buffer_load_dwordx4 v[56:59], v125, s[40:43], s74 offen offset:1024 sc1
    s_waitcnt vmcnt(0)
    v_cmp_eq_u32 vcc, -1, v59
    s_cbranch_vccz G_c54
    s_sub_u32 s52, s52, 1
    s_cbranch_scc0 G_c54_r
    s_mov_b32 s52, 0
    s_branch G_c54
G_c55_r:
    buffer_load_dwordx4 v[60:63], v125, s[40:43], s74 offen offset:2048 sc1
    s_waitcnt vmcnt(0)
    v_cmp_eq_u32 vcc, -1, v63
    s_cbranch_vccz G_c55
    s_sub_u32 s52, s52, 1
    s_cbranch_scc0 G_c55_r
    s_mov_b32 s52, 0
    s_branch G_c55
G_c56_r:
    buffer_load_dwordx4 v[32:35], v125, s[40:43], s74 offen offset:3072 sc1
    s_waitcnt vmcnt(0)
    v_cmp_eq_u32 vcc, -1, v35
    s_cbranch_vccz G_c56
    s_sub_u32 s52, s52, 1
    s_cbranch_scc0 G_c56_r
    s_mov_b32 s52, 0
    s_branch G_c56
G_c57_r:
    buffer_load_dwordx4 v[36:39], v125, s[40:43], s75 offen offset:0 sc1
    s_waitcnt vmcnt(0)
    v_cmp_eq_u32 vcc, -1, v39
    s_cbranch_vccz G_c57
    s_sub_u32 s52, s52, 1
    s_cbranch_scc0 G_c57_r
    s_mov_b32 s52, 0
    s_branch G_c57
G_c58_r:
    buffer_load_dwordx4 v[40:43], v125, s[40:43], s75 offen offset:1024 sc1
    s_waitcnt vmcnt(0)
    v_cmp_eq_u32 vcc, -1, v43
    s_cbranch_vccz G_c58
    s_sub_u32 s52, s52, 1
    s_cbranch_scc0 G_c58_r
    s_mov_b32 s52, 0
    s_branch G_c58
G_c59_r:
    buffer_load_dwordx4 v[44:47], v125, s[40:43], s75 offen offset:2048 sc1
    s_waitcnt vmcnt(0)
    v_cmp_eq_u32 vcc, -1, v47
    s_cbranch_vccz G_c59
    s_sub_u32 s52, s52, 1
    s_cbranch_scc0 G_c59_r
    s_mov_b32 s52, 0
    s_branch G_c59
P4_idle:
    s_mov_b32 s76, 0x40000000
    v_lshlrev_b32 v2, 7, v0
    s_add_u32 s66, s72, 0x10000
P4_ip:
    buffer_load_dword v1, v2, s[40:43], s66 offen offset:124 sc1
    s_waitcnt vmcnt(0)
    v_cmp_eq_u32 vcc, -1, v1
    s_cbranch_vccz P4_ip_ok
    s_sub_u32 s52, s52, 1
    s_cbranch_scc0 P4_ip
    s_mov_b32 s52, 0
P4_ip_ok:
    s_add_u32 s66, s72, 131072
    buffer_load_dword v1, v2, s[40:43], s66 offen sc1
    s_add_u32 s66, s72, 196608
    buffer_load_dword v1, v2, s[40:43], s66 offen sc1
    s_barrier
    v_lshlrev_b32 v112, 16, v113
    v_and_b32 v113, 0xffff0000, v113
    v_lshlrev_b32 v114, 16, v114
    s_add_u32 m0, s86, 0
    s_add_u32 s66, s85, 262144
    buffer_load_dwordx4 v8, s[24:27], s66 offen offset:0 lds
    buffer_load_dwordx4 v9, s[24:27], s66 offen offset:1024 lds
    s_add_u32 m0, s86, 2048
    s_add_u32 s66, s85, 327680
    buffer_load_dwordx4 v8, s[24:27], s66 offen offset:0 lds
    buffer_load_dwordx4 v9, s[24:27], s66 offen offset:1024 lds
    s_waitcnt vmcnt(0)
    ds_read_b64_tr_b16 a[0:1], v12 offset:0
    ds_read_b64_tr_b16 a[2:3], v12 offset:512
    ds_read_b64_tr_b16 a[4:5], v13 offset:0
    ds_read_b64_tr_b16 a[6:7], v13 offset:512
    ds_read_b64_tr_b16 a[8:9], v14 offset:0
    ds_read_b64_tr_b16 a[10:11], v14 offset:512
    ds_read_b64_tr_b16 a[12:13], v15 offset:0
    ds_read_b64_tr_b16 a[14:15], v15 offset:512
    s_waitcnt lgkmcnt(0)
    s_add_u32 m0, s86, 0
    s_add_u32 s66, s85, 655360
    buffer_load_dwordx4 v8, s[24:27], s66 offen offset:0 lds
    buffer_load_dwordx4 v9, s[24:27], s66 offen offset:1024 lds
    s_add_u32 m0, s86, 2048
    s_add_u32 s66, s85, 720896
    buffer_load_dwordx4 v8, s[24:27], s66 offen offset:0 lds
    buffer_load_dwordx4 v9, s[24:27], s66 offen offset:1024 lds
    ds_read_b64_tr_b16 a[16:17], v12 offset:32768
    ds_read_b64_tr_b16 a[18:19], v12 offset:33280
    ds_read_b64_tr_b16 a[20:21], v13 offset:32768
    ds_read_b64_tr_b16 a[22:23], v13 offset:33280
    ds_read_b64_tr_b16 a[24:25], v14 offset:32768
    ds_read_b64_tr_b16 a[26:27], v14 offset:33280
    ds_read_b64_tr_b16 a[28:29], v15 offset:32768
    ds_read_b64_tr_b16 a[30:31], v15 offset:33280
    s_waitcnt lgkmcnt(0)
    s_add_u32 m0, s86, 32768
    s_add_u32 s66, s85, 786432
    buffer_load_dwordx4 v8, s[24:27], s66 offen offset:0 lds
    buffer_load_dwordx4 v9, s[24:27], s66 offen offset:1024 lds
    s_add_u32 m0, s86, 34816
    s_add_u32 s66, s85, 851968
    buffer_load_dwordx4 v8, s[24:27], s66 offen offset:0 lds
    buffer_load_dwordx4 v9, s[24:27], s66 offen offset:1024 lds
    v_xor_b32 v12, 0x10000, v12
    v_xor_b32 v13, 0x10000, v13
    v_xor_b32 v14, 0x10000, v14
    v_xor_b32 v15, 0x10000, v15
    ds_read_b64_tr_b16 a[32:33], v12 offset:0
    ds_read_b64_tr_b16 a[34:35], v12 offset:512
    ds_read_b64_tr_b16 a[36:37], v13 offset:0
    ds_read_b64_tr_b16 a[38:39], v13 offset:512
    ds_read_b64_tr_b16 a[40:41], v14 offset:0
    ds_read_b64_tr_b16 a[42:43], v14 offset:512
    ds_read_b64_tr_b16 a[44:45], v15 offset:0
    ds_read_b64_tr_b16 a[46:47], v15 offset:512
    v_xor_b32 v12, 0x10000, v12
    v_xor_b32 v13, 0x10000, v13
    v_xor_b32 v14, 0x10000, v14
    v_xor_b32 v15, 0x10000, v15
    s_waitcnt lgkmcnt(0)
    v_min_u32 v2, 6, v0
    v_lshlrev_b32 v2, 10, v2
    v_add_u32 v2, 0, v2
    s_mov_b64 exec, 0xff
P5_p:
    buffer_load_dword v1, v2, s[40:43], s74 offen offset:1020 sc1
    s_waitcnt vmcnt(0)
    v_cmp_eq_u32 vcc, -1, v1
    s_cbranch_vccz P5_p_ok
    s_sub_u32 s52, s52, 1
    s_cbranch_scc0 P5_p
    s_mov_b32 s52, 0
P5_p_ok:
    s_mov_b64 exec, -1
    v_add_u32 v124, 0, v4
    buffer_load_dwordx4 v[32:35], v124, s[40:43], s74 offen offset:0 sc1
    buffer_load_dwordx4 v[36:39], v124, s[40:43], s74 offen offset:1024 sc1
    buffer_load_dwordx4 v[40:43], v124, s[40:43], s74 offen offset:2048 sc1
    buffer_load_dwordx4 v[44:47], v124, s[40:43], s74 offen offset:3072 sc1
    buffer_load_dwordx4 v[48:51], v124, s[40:43], s75 offen offset:0 sc1
    buffer_load_dwordx4 v[52:55], v124, s[40:43], s75 offen offset:1024 sc1
    buffer_load_dwordx4 v[56:59], v124, s[40:43], s75 offen offset:2048 sc1
    v_add_u32 v125, 57344, v4
    buffer_load_dwordx4 v[60:63], v125, s[40:43], s74 offen offset:0 sc1
    s_waitcnt vmcnt(0)
    v_cmp_eq_u32 vcc, -1, v35
    s_branch P5_entry
L_code_end:
.section .rodata,"a"
.p2align 6
.amdhsa_kernel sequential_preLN__softmax_full_mha__mixer_token_mlp__prompt_kernel
  .amdhsa_next_free_vgpr 256
  .amdhsa_next_free_sgpr 102
  .amdhsa_accum_offset 128
  .amdhsa_group_segment_fixed_size 0
  .amdhsa_kernarg_size 88
  .amdhsa_user_sgpr_count 2
  .amdhsa_user_sgpr_kernarg_segment_ptr 1
  .amdhsa_system_sgpr_workgroup_id_x 1
.end_amdhsa_kernel
```
